```python
import torch

def _softmax(x, axis=-1):
    return torch.softmax(x, dim=axis)
def _gelu(x):
    return torch.nn.functional.gelu(x, approximate="tanh")
def _silu(x):
    return torch.nn.functional.silu(x)
def _sigmoid(x):
    return torch.sigmoid(x)
def _layernorm(x, axis=-1, eps=1e-5):
    m = x.mean(dim=axis, keepdim=True)
    v = x.var(dim=axis, keepdim=True, unbiased=False)
    return (x - m) / torch.sqrt(v + eps)
def _scatter_add(tgt, idx, src, axis=0):
    return tgt.clone().index_add_(axis, idx, src)
def _segment_sum(src, seg, n):
    out = torch.zeros((n,) + src.shape[1:], dtype=src.dtype)
    return out.index_add_(0, seg, src)
def _pad(x, pw):
    flat = tuple(v for pair in reversed(pw) for v in pair)
    return torch.nn.functional.pad(x, flat)

kernel_name = 'parallel_sum__mha_block__dense_activation_gelu__prompt'

def setup_inputs():

    _w = (lambda a: (lambda t: t.to(torch.bfloat16) if t.is_floating_point() else t)(torch.as_tensor(a)))
    def _A_setup():
        B, S, D, H = 1, 2048, 640, 32
        return {
            "x": _w((lambda *s: torch.randn(*s, dtype=torch.bfloat16) * 0.05)(B, S, D)),
            "wqkv": _w((lambda *s: torch.randn(*s, dtype=torch.bfloat16) * 0.05)(D, 3 * D)),
            "wo": _w((lambda *s: torch.randn(*s, dtype=torch.bfloat16) * 0.05)(D, D)),
        }
    _A_in = _A_setup()

    def _B_setup():
        B, S, D, F = 1, 2048, 640, 1728
        return {
            "x": _w((lambda *s: torch.randn(*s, dtype=torch.bfloat16) * 0.05)(B, S, D)),
            "w1": _w((lambda *s: torch.randn(*s, dtype=torch.bfloat16) * 1.6)(D, F) * (D ** -0.5)),
            "b1": _w((lambda *s: torch.randn(*s, dtype=torch.bfloat16) * 1.6)(F) * 0.01),
            "w2": _w((lambda *s: torch.randn(*s, dtype=torch.bfloat16) * 0.2)(F, D) * (F ** -0.5)),
            "b2": _w((lambda *s: torch.randn(*s, dtype=torch.bfloat16) * 0.2)(D) * 0.01),
        }
    _B_in = _B_setup()

    return {
        "A_x": _A_in["x"],
        "A_wqkv": _A_in["wqkv"],
        "A_wo": _A_in["wo"],
        "B_x": _B_in["x"],
        "B_w1": _B_in["w1"],
        "B_b1": _B_in["b1"],
        "B_w2": _B_in["w2"],
        "B_b2": _B_in["b2"],
    }

def reference(A_x, A_wqkv, A_wo, B_x, B_w1, B_b1, B_w2, B_b2):
    def _A_ref(x, wqkv, wo):
        B, S, D = x.shape
        H = 32
        Dh = D // H
        qkv = (lambda x, *d: x.permute(*d))((x @ wqkv).reshape(B, S, 3, H, Dh), 2, 0, 3, 1, 4)
        q, k, v = qkv[0], qkv[1], qkv[2]
        scores = torch.einsum("bhqd,bhkd->bhqk", q, k) * (Dh ** -0.5)
        p = _softmax(scores, axis=-1)
        o = torch.einsum("bhqk,bhkd->bhqd", p, v)
        return (lambda x, *d: x.permute(*d))(o, 0, 2, 1, 3).reshape(B, S, D) @ wo

    def _B_ref(x, w1, b1, w2, b2):
        h = torch.einsum("bsd,df->bsf", x, w1) + b1
        h = _gelu(h)
        return torch.einsum("bsf,fd->bsd", h, w2) + b2

    x = A_x
    xn = _layernorm(x, axis=-1)
    return x + _A_ref(xn, A_wqkv, A_wo) + _B_ref(xn, B_w1, B_b1, B_w2, B_b2)
```

```asm
; @launch grid=(256,1,1) block=(768,1,1) lds=163840
.amdgcn_target "amdgcn-amd-amdhsa--gfx950"
.text
.p2align 8
.globl parallel_sum__mha_block__dense_activation_gelu__prompt_kernel
.type parallel_sum__mha_block__dense_activation_gelu__prompt_kernel,@function
parallel_sum__mha_block__dense_activation_gelu__prompt_kernel:
    s_cmp_ge_u32 s2, 256
    s_cbranch_scc1 K1_END
    s_load_dwordx4 s[4:7], s[0:1], 0
    s_load_dwordx2 s[8:9], s[0:1], 16
    s_load_dwordx4 s[12:15], s[0:1], 32
    s_load_dwordx2 s[16:17], s[0:1], 48
    s_load_dwordx2 s[18:19], s[0:1], 80
    s_load_dwordx2 s[10:11], s[0:1], 72
    s_mov_b32 s72, 0
    v_mov_b32 v128, 0x40000000
    v_mov_b32 v129, 0x40000000
    v_and_b32 v1, 63, v0
    v_lshrrev_b32 v72, 6, v0
    s_and_b32 s62, s2, 7
    v_readfirstlane_b32 s44, v72
    s_lshr_b32 s63, s2, 3
    s_lshl_b32 s47, s62, 1
    s_add_u32 s47, s47, s63
    s_mov_b32 s48, 15
    s_cmp_lt_u32 s63, 2
    s_cbranch_scc1 K1_TRANS
    s_lshr_b32 s64, s62, 1
    s_mul_i32 s64, s64, 30
    s_add_u32 s64, s64, s63
    s_sub_u32 s64, s64, 2
    s_lshr_b32 s48, s64, 3
    s_and_b32 s74, s48, 3
    s_lshl_b32 s65, s48, 2
    s_lshr_b32 s48, s48, 2
    s_mul_i32 s48, s48, 15
    s_sub_u32 s48, s65, s48
    s_and_b32 s64, s64, 7
    s_and_b32 s65, s62, 1
    s_lshl_b32 s65, s65, 3
    s_add_u32 s47, s64, s65
    s_lshl_b32 s50, s48, 3
    s_min_u32 s50, s50, 100
    s_cmp_ge_u32 s44, 4
    s_cbranch_scc1 K1_COMP
    s_lshl_b32 s62, s47, 7
    s_lshl_b32 s63, s44, 4
    s_add_u32 s62, s62, s63
    v_lshrrev_b32 v72, 3, v1
    v_add_u32 v72, s62, v72
    v_lshrrev_b32 v73, 1, v72
    v_xor_b32 v73, v73, v1
    v_and_b32 v73, 7, v73
    v_mul_u32_u24 v72, 1280, v72
    v_lshl_add_u32 v2, v73, 4, v72
    v_xor_b32 v73, 4, v73
    v_lshl_add_u32 v3, v73, 4, v72
    v_add_u32 v3, 10240, v3
    s_lshl_b32 s59, s44, 11
    s_and_b32 s62, s44, 1
    s_lshl_b32 s62, s62, 1
    s_lshr_b32 s63, s44, 1
    s_lshl_b32 s63, s63, 3
    s_or_b32 s62, s62, s63
    v_bfe_u32 v72, v1, 4, 1
    v_lshlrev_b32 v72, 2, v72
    v_lshrrev_b32 v73, 5, v1
    v_lshl_or_b32 v72, v73, 4, v72
    v_or_b32 v72, s62, v72
    v_and_b32 v73, 15, v1
    v_lshlrev_b32 v73, 4, v73
    s_lshl_b32 s64, s48, 8
    s_lshl_b32 s65, s50, 5
    v_mul_u32_u24 v4, 3840, v72
    v_add3_u32 v4, v4, v73, s64
    v_add_u32 v5, 3840, v4
    v_mul_u32_u24 v6, 3456, v72
    v_add3_u32 v6, v6, v73, s65
    v_add_u32 v7, 3456, v6
    s_mul_i32 s60, s44, 2112
    s_add_u32 s60, s60, 16384
    s_mov_b32 s51, 0
    s_mov_b32 s76, 81920
    s_mov_b32 s52, 0
    s_mov_b32 s77, 122880
    s_mov_b32 s53, 0
    s_mov_b32 s78, 110592
    s_mov_b32 s54, s59
    s_mov_b32 s55, s60
    s_waitcnt lgkmcnt(0)
    s_mov_b32 s20, s4
    s_mov_b32 s21, s5
    s_mov_b32 s22, 0x00280000
    s_mov_b32 s23, 0x00020000
    s_mov_b32 s24, s6
    s_mov_b32 s25, s7
    s_mov_b32 s26, 0x00258000
    s_mov_b32 s27, 0x00020000
    s_mov_b32 s28, s12
    s_mov_b32 s29, s13
    s_mov_b32 s30, 0x0021c000
    s_mov_b32 s31, 0x00020000
    s_mov_b32 m0, s54
    s_nop 0
    buffer_load_dwordx4 v2, s[20:23], s51 offen lds
    s_add_u32 m0, s54, 1024
    s_nop 0
    buffer_load_dwordx4 v3, s[20:23], s51 offen lds
    s_add_u32 s51, s51, 128
    s_add_u32 m0, s54, 8192
    s_nop 0
    buffer_load_dwordx4 v2, s[20:23], s76 offen lds
    s_add_u32 m0, s54, 9216
    s_nop 0
    buffer_load_dwordx4 v3, s[20:23], s76 offen lds
    s_add_u32 s76, s76, 128
    s_mov_b32 m0, s55
    s_nop 0
    buffer_load_dwordx4 v4, s[24:27], s52 offen lds
    s_add_u32 m0, s55, 1056
    s_nop 0
    buffer_load_dwordx4 v5, s[24:27], s52 offen lds
    s_add_u32 s52, s52, 245760
    s_add_u32 m0, s55, 16896
    s_nop 0
    buffer_load_dwordx4 v6, s[28:31], s53 offen lds
    s_add_u32 m0, s55, 17952
    s_nop 0
    buffer_load_dwordx4 v7, s[28:31], s53 offen lds
    s_add_u32 s53, s53, 221184
    s_add_u32 m0, s55, 8448
    s_nop 0
    buffer_load_dwordx4 v4, s[24:27], s77 offen lds
    s_add_u32 m0, s55, 9504
    s_nop 0
    buffer_load_dwordx4 v5, s[24:27], s77 offen lds
    s_add_u32 s77, s77, 245760
    s_add_u32 m0, s55, 25344
    s_nop 0
    buffer_load_dwordx4 v6, s[28:31], s78 offen lds
    s_add_u32 m0, s55, 26400
    s_nop 0
    buffer_load_dwordx4 v7, s[28:31], s78 offen lds
    s_add_u32 s78, s78, 221184
    s_add_u32 s54, s54, 50176
    s_add_u32 s55, s55, 50176
    s_cmp_ge_u32 s54, 150528
    s_cselect_b32 s54, s59, s54
    s_cselect_b32 s55, s60, s55
    s_mov_b32 s40, s14
    s_mov_b32 s41, s15
    s_mov_b32 s42, 0x00000d80
    s_mov_b32 s43, 0x00020000
    v_lshlrev_b32 v72, 2, v1
    buffer_load_dword v8, v72, s[40:43], s65 offen
    s_mov_b32 m0, s54
    s_nop 0
    buffer_load_dwordx4 v2, s[20:23], s51 offen lds
    s_add_u32 m0, s54, 1024
    s_nop 0
    buffer_load_dwordx4 v3, s[20:23], s51 offen lds
    s_add_u32 s51, s51, 128
    s_add_u32 m0, s54, 8192
    s_nop 0
    buffer_load_dwordx4 v2, s[20:23], s76 offen lds
    s_add_u32 m0, s54, 9216
    s_nop 0
    buffer_load_dwordx4 v3, s[20:23], s76 offen lds
    s_add_u32 s76, s76, 128
    s_mov_b32 m0, s55
    s_nop 0
    buffer_load_dwordx4 v4, s[24:27], s52 offen lds
    s_add_u32 m0, s55, 1056
    s_nop 0
    buffer_load_dwordx4 v5, s[24:27], s52 offen lds
    s_add_u32 s52, s52, 245760
    s_add_u32 m0, s55, 16896
    s_nop 0
    buffer_load_dwordx4 v6, s[28:31], s53 offen lds
    s_add_u32 m0, s55, 17952
    s_nop 0
    buffer_load_dwordx4 v7, s[28:31], s53 offen lds
    s_add_u32 s53, s53, 221184
    s_add_u32 m0, s55, 8448
    s_nop 0
    buffer_load_dwordx4 v4, s[24:27], s77 offen lds
    s_add_u32 m0, s55, 9504
    s_nop 0
    buffer_load_dwordx4 v5, s[24:27], s77 offen lds
    s_add_u32 s77, s77, 245760
    s_add_u32 m0, s55, 25344
    s_nop 0
    buffer_load_dwordx4 v6, s[28:31], s78 offen lds
    s_add_u32 m0, s55, 26400
    s_nop 0
    buffer_load_dwordx4 v7, s[28:31], s78 offen lds
    s_add_u32 s78, s78, 221184
    s_add_u32 s54, s54, 50176
    s_add_u32 s55, s55, 50176
    s_cmp_ge_u32 s54, 150528
    s_cselect_b32 s54, s59, s54
    s_cselect_b32 s55, s60, s55
    v_and_b32 v73, 31, v1
    v_lshrrev_b32 v74, 5, v1
    v_lshlrev_b32 v74, 2, v74
    v_bfe_u32 v75, v1, 1, 3
    v_xor_b32 v74, v74, v75
    v_lshlrev_b32 v74, 4, v74
    v_lshl_add_u32 v74, v73, 7, v74
    s_lshl_b32 s62, s44, 12
    v_add_u32 v10, s62, v74
    v_xor_b32 v11, 16, v10
    v_xor_b32 v12, 32, v10
    v_xor_b32 v13, 48, v10
    v_mov_b32 v36, 0
    v_mov_b32 v37, 0
    v_mov_b32 v38, 0
    v_mov_b32 v39, 0
    s_mov_b32 s56, 0
    s_mov_b32 s58, 0
    s_waitcnt vmcnt(12)
    v_add_u32 v72, 152576, v72
    ds_write_b32 v72, v8
    v_mov_b32 v76, 153600
    ds_write_b128 v76, v[36:39]
    s_barrier
    v_add_u32 v14, s56, v10
    v_add_u32 v15, s56, v11
    v_add_u32 v16, s56, v12
    v_add_u32 v17, s56, v13
    ds_read_b128 v[20:23], v14
    ds_read_b128 v[24:27], v15
    ds_read_b128 v[28:31], v16
    ds_read_b128 v[32:35], v17
    s_add_u32 s56, s56, 50176
    s_cmp_eq_u32 s56, 150528
    s_cselect_b32 s56, 0, s56
    s_mov_b32 m0, s54
    s_nop 0
    buffer_load_dwordx4 v2, s[20:23], s51 offen lds
    s_add_u32 m0, s54, 1024
    s_nop 0
    buffer_load_dwordx4 v3, s[20:23], s51 offen lds
    s_waitcnt lgkmcnt(0)
    v_lshlrev_b32 v40, 16, v20
    v_and_b32 v41, 0xffff0000, v20
    v_add_f32 v36, v36, v40
    v_add_f32 v37, v37, v41
    v_fmac_f32 v38, v40, v40
    v_fmac_f32 v39, v41, v41
    v_lshlrev_b32 v42, 16, v21
    v_and_b32 v43, 0xffff0000, v21
    v_add_f32 v36, v36, v42
    s_add_u32 s51, s51, 128
    s_add_u32 m0, s54, 8192
    s_nop 0
    buffer_load_dwordx4 v2, s[20:23], s76 offen lds
    v_add_f32 v37, v37, v43
    v_fmac_f32 v38, v42, v42
    v_fmac_f32 v39, v43, v43
    v_lshlrev_b32 v40, 16, v22
    v_and_b32 v41, 0xffff0000, v22
    v_add_f32 v36, v36, v40
    v_add_f32 v37, v37, v41
    v_fmac_f32 v38, v40, v40
    v_fmac_f32 v39, v41, v41
    s_add_u32 m0, s54, 9216
    s_nop 0
    buffer_load_dwordx4 v3, s[20:23], s76 offen lds
    v_lshlrev_b32 v42, 16, v23
    v_and_b32 v43, 0xffff0000, v23
    v_add_f32 v36, v36, v42
    v_add_f32 v37, v37, v43
    v_fmac_f32 v38, v42, v42
    v_fmac_f32 v39, v43, v43
    v_lshlrev_b32 v40, 16, v24
    v_and_b32 v41, 0xffff0000, v24
    v_add_f32 v36, v36, v40
    s_add_u32 s76, s76, 128
    s_mov_b32 m0, s55
    s_nop 0
    buffer_load_dwordx4 v4, s[24:27], s52 offen lds
    v_add_f32 v37, v37, v41
    v_fmac_f32 v38, v40, v40
    v_fmac_f32 v39, v41, v41
    v_lshlrev_b32 v42, 16, v25
    v_and_b32 v43, 0xffff0000, v25
    v_add_f32 v36, v36, v42
    v_add_f32 v37, v37, v43
    v_fmac_f32 v38, v42, v42
    v_fmac_f32 v39, v43, v43
    s_add_u32 m0, s55, 1056
    s_nop 0
    buffer_load_dwordx4 v5, s[24:27], s52 offen lds
    v_lshlrev_b32 v40, 16, v26
    v_and_b32 v41, 0xffff0000, v26
    v_add_f32 v36, v36, v40
    v_add_f32 v37, v37, v41
    v_fmac_f32 v38, v40, v40
    v_fmac_f32 v39, v41, v41
    v_lshlrev_b32 v42, 16, v27
    v_and_b32 v43, 0xffff0000, v27
    v_add_f32 v36, v36, v42
    s_add_u32 s52, s52, 245760
    s_add_u32 m0, s55, 16896
    s_nop 0
    buffer_load_dwordx4 v6, s[28:31], s53 offen lds
    v_add_f32 v37, v37, v43
    v_fmac_f32 v38, v42, v42
    v_fmac_f32 v39, v43, v43
    v_lshlrev_b32 v40, 16, v28
    v_and_b32 v41, 0xffff0000, v28
    v_add_f32 v36, v36, v40
    v_add_f32 v37, v37, v41
    v_fmac_f32 v38, v40, v40
    v_fmac_f32 v39, v41, v41
    s_add_u32 m0, s55, 17952
    s_nop 0
    buffer_load_dwordx4 v7, s[28:31], s53 offen lds
    v_lshlrev_b32 v42, 16, v29
    v_and_b32 v43, 0xffff0000, v29
    v_add_f32 v36, v36, v42
    v_add_f32 v37, v37, v43
    v_fmac_f32 v38, v42, v42
    v_fmac_f32 v39, v43, v43
    v_lshlrev_b32 v40, 16, v30
    v_and_b32 v41, 0xffff0000, v30
    v_add_f32 v36, v36, v40
    s_add_u32 s53, s53, 221184
    s_add_u32 m0, s55, 8448
    s_nop 0
    buffer_load_dwordx4 v4, s[24:27], s77 offen lds
    v_add_f32 v37, v37, v41
    v_fmac_f32 v38, v40, v40
    v_fmac_f32 v39, v41, v41
    v_lshlrev_b32 v42, 16, v31
    v_and_b32 v43, 0xffff0000, v31
    v_add_f32 v36, v36, v42
    v_add_f32 v37, v37, v43
    v_fmac_f32 v38, v42, v42
    v_fmac_f32 v39, v43, v43
    s_add_u32 m0, s55, 9504
    s_nop 0
    buffer_load_dwordx4 v5, s[24:27], s77 offen lds
    v_lshlrev_b32 v40, 16, v32
    v_and_b32 v41, 0xffff0000, v32
    v_add_f32 v36, v36, v40
    v_add_f32 v37, v37, v41
    v_fmac_f32 v38, v40, v40
    v_fmac_f32 v39, v41, v41
    v_lshlrev_b32 v42, 16, v33
    v_and_b32 v43, 0xffff0000, v33
    v_add_f32 v36, v36, v42
    s_add_u32 s77, s77, 245760
    s_add_u32 m0, s55, 25344
    s_nop 0
    buffer_load_dwordx4 v6, s[28:31], s78 offen lds
    v_add_f32 v37, v37, v43
    v_fmac_f32 v38, v42, v42
    v_fmac_f32 v39, v43, v43
    v_lshlrev_b32 v40, 16, v34
    v_and_b32 v41, 0xffff0000, v34
    v_add_f32 v36, v36, v40
    v_add_f32 v37, v37, v41
    v_fmac_f32 v38, v40, v40
    v_fmac_f32 v39, v41, v41
    s_add_u32 m0, s55, 26400
    s_nop 0
    buffer_load_dwordx4 v7, s[28:31], s78 offen lds
    v_lshlrev_b32 v42, 16, v35
    v_and_b32 v43, 0xffff0000, v35
    v_add_f32 v36, v36, v42
    v_add_f32 v37, v37, v43
    v_fmac_f32 v38, v42, v42
    v_fmac_f32 v39, v43, v43
    s_add_u32 s78, s78, 221184
    s_add_u32 s54, s54, 50176
    s_add_u32 s55, s55, 50176
    s_cmp_ge_u32 s54, 150528
    s_cselect_b32 s54, s59, s54
    s_cselect_b32 s55, s60, s55
K1_LD:
    s_waitcnt vmcnt(12)
    s_barrier
    v_add_u32 v14, s56, v10
    v_add_u32 v15, s56, v11
    v_add_u32 v16, s56, v12
    v_add_u32 v17, s56, v13
    ds_read_b128 v[20:23], v14
    ds_read_b128 v[24:27], v15
    ds_read_b128 v[28:31], v16
    ds_read_b128 v[32:35], v17
    s_add_u32 s56, s56, 50176
    s_cmp_eq_u32 s56, 150528
    s_cselect_b32 s56, 0, s56
    s_mov_b32 m0, s54
    s_nop 0
    buffer_load_dwordx4 v2, s[20:23], s51 offen lds
    s_add_u32 m0, s54, 1024
    s_nop 0
    buffer_load_dwordx4 v3, s[20:23], s51 offen lds
    s_waitcnt lgkmcnt(0)
    v_lshlrev_b32 v40, 16, v20
    v_and_b32 v41, 0xffff0000, v20
    v_add_f32 v36, v36, v40
    v_add_f32 v37, v37, v41
    v_fmac_f32 v38, v40, v40
    v_fmac_f32 v39, v41, v41
    v_lshlrev_b32 v42, 16, v21
    v_and_b32 v43, 0xffff0000, v21
    v_add_f32 v36, v36, v42
    s_add_u32 s51, s51, 128
    s_add_u32 m0, s54, 8192
    s_nop 0
    buffer_load_dwordx4 v2, s[20:23], s76 offen lds
    v_add_f32 v37, v37, v43
    v_fmac_f32 v38, v42, v42
    v_fmac_f32 v39, v43, v43
    v_lshlrev_b32 v40, 16, v22
    v_and_b32 v41, 0xffff0000, v22
    v_add_f32 v36, v36, v40
    v_add_f32 v37, v37, v41
    v_fmac_f32 v38, v40, v40
    v_fmac_f32 v39, v41, v41
    s_add_u32 m0, s54, 9216
    s_nop 0
    buffer_load_dwordx4 v3, s[20:23], s76 offen lds
    v_lshlrev_b32 v42, 16, v23
    v_and_b32 v43, 0xffff0000, v23
    v_add_f32 v36, v36, v42
    v_add_f32 v37, v37, v43
    v_fmac_f32 v38, v42, v42
    v_fmac_f32 v39, v43, v43
    v_lshlrev_b32 v40, 16, v24
    v_and_b32 v41, 0xffff0000, v24
    v_add_f32 v36, v36, v40
    s_add_u32 s76, s76, 128
    s_mov_b32 m0, s55
    s_nop 0
    buffer_load_dwordx4 v4, s[24:27], s52 offen lds
    v_add_f32 v37, v37, v41
    v_fmac_f32 v38, v40, v40
    v_fmac_f32 v39, v41, v41
    v_lshlrev_b32 v42, 16, v25
    v_and_b32 v43, 0xffff0000, v25
    v_add_f32 v36, v36, v42
    v_add_f32 v37, v37, v43
    v_fmac_f32 v38, v42, v42
    v_fmac_f32 v39, v43, v43
    s_add_u32 m0, s55, 1056
    s_nop 0
    buffer_load_dwordx4 v5, s[24:27], s52 offen lds
    v_lshlrev_b32 v40, 16, v26
    v_and_b32 v41, 0xffff0000, v26
    v_add_f32 v36, v36, v40
    v_add_f32 v37, v37, v41
    v_fmac_f32 v38, v40, v40
    v_fmac_f32 v39, v41, v41
    v_lshlrev_b32 v42, 16, v27
    v_and_b32 v43, 0xffff0000, v27
    v_add_f32 v36, v36, v42
    s_add_u32 s52, s52, 245760
    s_add_u32 m0, s55, 16896
    s_nop 0
    buffer_load_dwordx4 v6, s[28:31], s53 offen lds
    v_add_f32 v37, v37, v43
    v_fmac_f32 v38, v42, v42
    v_fmac_f32 v39, v43, v43
    v_lshlrev_b32 v40, 16, v28
    v_and_b32 v41, 0xffff0000, v28
    v_add_f32 v36, v36, v40
    v_add_f32 v37, v37, v41
    v_fmac_f32 v38, v40, v40
    v_fmac_f32 v39, v41, v41
    s_add_u32 m0, s55, 17952
    s_nop 0
    buffer_load_dwordx4 v7, s[28:31], s53 offen lds
    v_lshlrev_b32 v42, 16, v29
    v_and_b32 v43, 0xffff0000, v29
    v_add_f32 v36, v36, v42
    v_add_f32 v37, v37, v43
    v_fmac_f32 v38, v42, v42
    v_fmac_f32 v39, v43, v43
    v_lshlrev_b32 v40, 16, v30
    v_and_b32 v41, 0xffff0000, v30
    v_add_f32 v36, v36, v40
    s_add_u32 s53, s53, 221184
    s_add_u32 m0, s55, 8448
    s_nop 0
    buffer_load_dwordx4 v4, s[24:27], s77 offen lds
    v_add_f32 v37, v37, v41
    v_fmac_f32 v38, v40, v40
    v_fmac_f32 v39, v41, v41
    v_lshlrev_b32 v42, 16, v31
    v_and_b32 v43, 0xffff0000, v31
    v_add_f32 v36, v36, v42
    v_add_f32 v37, v37, v43
    v_fmac_f32 v38, v42, v42
    v_fmac_f32 v39, v43, v43
    s_add_u32 m0, s55, 9504
    s_nop 0
    buffer_load_dwordx4 v5, s[24:27], s77 offen lds
    v_lshlrev_b32 v40, 16, v32
    v_and_b32 v41, 0xffff0000, v32
    v_add_f32 v36, v36, v40
    v_add_f32 v37, v37, v41
    v_fmac_f32 v38, v40, v40
    v_fmac_f32 v39, v41, v41
    v_lshlrev_b32 v42, 16, v33
    v_and_b32 v43, 0xffff0000, v33
    v_add_f32 v36, v36, v42
    s_add_u32 s77, s77, 245760
    s_add_u32 m0, s55, 25344
    s_nop 0
    buffer_load_dwordx4 v6, s[28:31], s78 offen lds
    v_add_f32 v37, v37, v43
    v_fmac_f32 v38, v42, v42
    v_fmac_f32 v39, v43, v43
    v_lshlrev_b32 v40, 16, v34
    v_and_b32 v41, 0xffff0000, v34
    v_add_f32 v36, v36, v40
    v_add_f32 v37, v37, v41
    v_fmac_f32 v38, v40, v40
    v_fmac_f32 v39, v41, v41
    s_add_u32 m0, s55, 26400
    s_nop 0
    buffer_load_dwordx4 v7, s[28:31], s78 offen lds
    v_lshlrev_b32 v42, 16, v35
    v_and_b32 v43, 0xffff0000, v35
    v_add_f32 v36, v36, v42
    v_add_f32 v37, v37, v43
    v_fmac_f32 v38, v42, v42
    v_fmac_f32 v39, v43, v43
    s_add_u32 s78, s78, 221184
    s_add_u32 s54, s54, 50176
    s_add_u32 s55, s55, 50176
    s_cmp_ge_u32 s54, 150528
    s_cselect_b32 s54, s59, s54
    s_cselect_b32 s55, s60, s55
    s_add_u32 s58, s58, 1
    s_cmp_lt_u32 s58, 7
    s_cbranch_scc1 K1_LD
    s_waitcnt vmcnt(12)
    s_barrier
    s_mov_b32 s58, 0
K1_LD2:
    v_add_u32 v14, s56, v10
    v_add_u32 v15, s56, v11
    v_add_u32 v16, s56, v12
    v_add_u32 v17, s56, v13
    ds_read_b128 v[20:23], v14
    ds_read_b128 v[24:27], v15
    ds_read_b128 v[28:31], v16
    ds_read_b128 v[32:35], v17
    s_add_u32 s56, s56, 50176
    s_cmp_eq_u32 s56, 150528
    s_cselect_b32 s56, 0, s56
    s_waitcnt lgkmcnt(0)
    v_lshlrev_b32 v40, 16, v20
    v_and_b32 v41, 0xffff0000, v20
    v_add_f32 v36, v36, v40
    v_add_f32 v37, v37, v41
    v_fmac_f32 v38, v40, v40
    v_fmac_f32 v39, v41, v41
    v_lshlrev_b32 v42, 16, v21
    v_and_b32 v43, 0xffff0000, v21
    v_add_f32 v36, v36, v42
    v_add_f32 v37, v37, v43
    v_fmac_f32 v38, v42, v42
    v_fmac_f32 v39, v43, v43
    v_lshlrev_b32 v40, 16, v22
    v_and_b32 v41, 0xffff0000, v22
    v_add_f32 v36, v36, v40
    v_add_f32 v37, v37, v41
    v_fmac_f32 v38, v40, v40
    v_fmac_f32 v39, v41, v41
    v_lshlrev_b32 v42, 16, v23
    v_and_b32 v43, 0xffff0000, v23
    v_add_f32 v36, v36, v42
    v_add_f32 v37, v37, v43
    v_fmac_f32 v38, v42, v42
    v_fmac_f32 v39, v43, v43
    v_lshlrev_b32 v40, 16, v24
    v_and_b32 v41, 0xffff0000, v24
    v_add_f32 v36, v36, v40
    v_add_f32 v37, v37, v41
    v_fmac_f32 v38, v40, v40
    v_fmac_f32 v39, v41, v41
    v_lshlrev_b32 v42, 16, v25
    v_and_b32 v43, 0xffff0000, v25
    v_add_f32 v36, v36, v42
    v_add_f32 v37, v37, v43
    v_fmac_f32 v38, v42, v42
    v_fmac_f32 v39, v43, v43
    v_lshlrev_b32 v40, 16, v26
    v_and_b32 v41, 0xffff0000, v26
    v_add_f32 v36, v36, v40
    v_add_f32 v37, v37, v41
    v_fmac_f32 v38, v40, v40
    v_fmac_f32 v39, v41, v41
    v_lshlrev_b32 v42, 16, v27
    v_and_b32 v43, 0xffff0000, v27
    v_add_f32 v36, v36, v42
    v_add_f32 v37, v37, v43
    v_fmac_f32 v38, v42, v42
    v_fmac_f32 v39, v43, v43
    v_lshlrev_b32 v40, 16, v28
    v_and_b32 v41, 0xffff0000, v28
    v_add_f32 v36, v36, v40
    v_add_f32 v37, v37, v41
    v_fmac_f32 v38, v40, v40
    v_fmac_f32 v39, v41, v41
    v_lshlrev_b32 v42, 16, v29
    v_and_b32 v43, 0xffff0000, v29
    v_add_f32 v36, v36, v42
    v_add_f32 v37, v37, v43
    v_fmac_f32 v38, v42, v42
    v_fmac_f32 v39, v43, v43
    v_lshlrev_b32 v40, 16, v30
    v_and_b32 v41, 0xffff0000, v30
    v_add_f32 v36, v36, v40
    v_add_f32 v37, v37, v41
    v_fmac_f32 v38, v40, v40
    v_fmac_f32 v39, v41, v41
    v_lshlrev_b32 v42, 16, v31
    v_and_b32 v43, 0xffff0000, v31
    v_add_f32 v36, v36, v42
    v_add_f32 v37, v37, v43
    v_fmac_f32 v38, v42, v42
    v_fmac_f32 v39, v43, v43
    v_lshlrev_b32 v40, 16, v32
    v_and_b32 v41, 0xffff0000, v32
    v_add_f32 v36, v36, v40
    v_add_f32 v37, v37, v41
    v_fmac_f32 v38, v40, v40
    v_fmac_f32 v39, v41, v41
    v_lshlrev_b32 v42, 16, v33
    v_and_b32 v43, 0xffff0000, v33
    v_add_f32 v36, v36, v42
    v_add_f32 v37, v37, v43
    v_fmac_f32 v38, v42, v42
    v_fmac_f32 v39, v43, v43
    v_lshlrev_b32 v40, 16, v34
    v_and_b32 v41, 0xffff0000, v34
    v_add_f32 v36, v36, v40
    v_add_f32 v37, v37, v41
    v_fmac_f32 v38, v40, v40
    v_fmac_f32 v39, v41, v41
    v_lshlrev_b32 v42, 16, v35
    v_and_b32 v43, 0xffff0000, v35
    v_add_f32 v36, v36, v42
    v_add_f32 v37, v37, v43
    v_fmac_f32 v38, v42, v42
    v_fmac_f32 v39, v43, v43
    s_cmp_eq_u32 s58, 1
    s_cbranch_scc1 K1_LD3
    s_cmp_lg_u32 s44, 0
    s_cbranch_scc1 ZD_ld
    s_mov_b32 s40, s10
    s_mov_b32 s41, s11
    s_mov_b32 s42, 0x00000100
    s_mov_b32 s43, 0x00020000
    v_mov_b32 v76, 0
    s_mov_b32 s69, 0
ZP_ld:
    buffer_load_dword v77, v76, s[40:43], 0 offen sc1
    s_add_u32 s69, s69, 1
    s_waitcnt vmcnt(0)
    v_readfirstlane_b32 s68, v77
    s_cmp_ge_u32 s69, 2097152
    s_cbranch_scc1 ZD_ld
    s_cmp_eq_u32 s68, 0
    s_cbranch_scc1 ZP_ld
ZD_ld:
    s_waitcnt vmcnt(0)
    s_barrier
    s_mov_b32 s58, 1
    s_branch K1_LD2
K1_LD3:
    v_add_f32 v36, v36, v37
    v_add_f32 v37, v38, v39
    v_mov_b32 v40, v36
    v_mov_b32 v41, v37
    s_nop 1
    v_permlane32_swap_b32 v36, v40
    v_permlane32_swap_b32 v37, v41
    v_add_f32 v36, v36, v40
    v_add_f32 v37, v37, v41
    v_mul_f32 v36, 0x3acccccd, v36
    v_mul_f32 v37, 0x3acccccd, v37
    v_fma_f32 v37, -v36, v36, v37
    v_max_f32 v37, 0, v37
    v_cvt_pk_bf16_f32 v37, v37, v37
    v_lshlrev_b32 v37, 16, v37
    v_add_f32 v37, 0x3727c5ac, v37
    v_cvt_pk_bf16_f32 v37, v37, v37
    v_lshlrev_b32 v37, 16, v37
    v_sqrt_f32 v37, v37
    v_cvt_pk_bf16_f32 v36, v36, v36
    v_lshlrev_b32 v36, 16, v36
    v_cvt_pk_bf16_f32 v37, v37, v37
    v_lshlrev_b32 v37, 16, v37
    v_rcp_f32 v39, v37
    v_sub_f32 v38, 0, v36
    v_lshlrev_b32 v73, 2, v73
    s_lshl_b32 s62, s44, 7
    s_add_u32 s62, s62, 150528
    v_add_u32 v73, s62, v73
    ds_write_b32 v73, v38
    ds_write_b32 v73, v39 offset:512
    s_waitcnt lgkmcnt(0)
    s_barrier
    s_lshl_b32 s62, s47, 7
    s_lshl_b32 s63, s48, 2
    s_add_u32 s62, s62, s63
    s_add_u32 s72, s62, 9216
    s_barrier
    s_branch P2_ENTRY
K1_COMP:
    s_and_b32 s45, s44, 1
    s_bfe_u32 s49, s44, 0x10001
    s_lshr_b32 s46, s44, 3
    s_lshl_b32 s62, s45, 13
    v_and_b32 v76, 15, v1
    v_lshrrev_b32 v72, 4, v1
    v_lshrrev_b32 v73, 1, v76
    v_xor_b32 v73, v73, v72
    v_lshlrev_b32 v73, 4, v73
    v_lshl_add_u32 v2, v76, 7, v73
    v_add_u32 v2, s62, v2
    v_xor_b32 v3, 64, v2
    v_bfe_u32 v73, v1, 2, 3
    v_mul_u32_u24 v73, 1056, v73
    v_lshrrev_b32 v74, 5, v1
    v_lshl_add_u32 v73, v74, 9, v73
    v_and_b32 v74, 3, v1
    v_lshl_add_u32 v73, v74, 3, v73
    s_mul_i32 s62, s46, 16896
    s_lshl_b32 s63, s49, 7
    s_add_u32 s62, s62, s63
    s_add_u32 s62, s62, 16384
    v_add_u32 v4, s62, v73
    v_mov_b32 v104, 0
    v_mov_b32 v105, 0
    v_mov_b32 v106, 0
    v_mov_b32 v107, 0
    v_mov_b32 v108, 0
    v_mov_b32 v109, 0
    v_mov_b32 v110, 0
    v_mov_b32 v111, 0
    v_mov_b32 v112, 0
    v_mov_b32 v113, 0
    v_mov_b32 v114, 0
    v_mov_b32 v115, 0
    v_mov_b32 v116, 0
    v_mov_b32 v117, 0
    v_mov_b32 v118, 0
    v_mov_b32 v119, 0
    v_mov_b32 v120, 0
    v_mov_b32 v121, 0
    v_mov_b32 v122, 0
    v_mov_b32 v123, 0
    v_mov_b32 v124, 0
    v_mov_b32 v125, 0
    v_mov_b32 v126, 0
    v_mov_b32 v127, 0
    v_mov_b32 v128, 0
    v_mov_b32 v129, 0
    v_mov_b32 v130, 0
    v_mov_b32 v131, 0
    v_mov_b32 v132, 0
    v_mov_b32 v133, 0
    v_mov_b32 v134, 0
    v_mov_b32 v135, 0
    v_mov_b32 v136, 0
    v_mov_b32 v137, 0
    v_mov_b32 v138, 0
    v_mov_b32 v139, 0
    v_mov_b32 v140, 0
    v_mov_b32 v141, 0
    v_mov_b32 v142, 0
    v_mov_b32 v143, 0
    v_mov_b32 v144, 0
    v_mov_b32 v145, 0
    v_mov_b32 v146, 0
    v_mov_b32 v147, 0
    v_mov_b32 v148, 0
    v_mov_b32 v149, 0
    v_mov_b32 v150, 0
    v_mov_b32 v151, 0
    v_mov_b32 v152, 0
    v_mov_b32 v153, 0
    v_mov_b32 v154, 0
    v_mov_b32 v155, 0
    v_mov_b32 v156, 0
    v_mov_b32 v157, 0
    v_mov_b32 v158, 0
    v_mov_b32 v159, 0
    v_mov_b32 v160, 0
    v_mov_b32 v161, 0
    v_mov_b32 v162, 0
    v_mov_b32 v163, 0
    v_mov_b32 v164, 0
    v_mov_b32 v165, 0
    v_mov_b32 v166, 0
    v_mov_b32 v167, 0
    v_cmp_eq_u32 vcc, 0, v76
    v_mov_b32 v77, 0x3f803f80
    s_nop 0
    v_mov_b32 v8, 0
    v_cndmask_b32 v20, 0, v77, vcc
    v_mov_b32 v9, 0
    v_cndmask_b32 v21, 0, v77, vcc
    v_mov_b32 v10, 0
    v_cndmask_b32 v22, 0, v77, vcc
    v_mov_b32 v11, 0
    v_cndmask_b32 v23, 0, v77, vcc
    v_mov_b32 v24, 0
    v_mov_b32 v12, 0x40000000
    v_mov_b32 v25, 0
    v_mov_b32 v13, 0x40000000
    v_mov_b32 v26, 0
    v_mov_b32 v14, 0x40000000
    v_mov_b32 v27, 0
    v_mov_b32 v15, 0x40000000
    v_mov_b32 v28, 0
    v_mov_b32 v16, 0x40000000
    v_mov_b32 v29, 0
    v_mov_b32 v17, 0x40000000
    v_mov_b32 v30, 0
    v_mov_b32 v18, 0x40000000
    v_mov_b32 v31, 0
    v_mov_b32 v19, 0x40000000
    s_mov_b32 s56, 0
    s_mov_b32 s58, 0
    s_mov_b32 s57, 0
    s_cmp_ge_u32 s48, 10
    s_cselect_b32 s73, 1, 0
    s_cmp_eq_u32 s46, 1
    s_cselect_b32 s73, 2, s73
    s_lshl_b32 s68, s47, 2
    s_lshl_b32 s69, s45, 1
    s_add_u32 s68, s68, s69
    s_cmp_eq_u32 s73, 1
    s_cbranch_scc1 K1_PRE_V
    s_cmp_eq_u32 s73, 2
    s_cbranch_scc1 K1_PRE_F
    s_cmp_lt_u32 s48, 5
    s_mov_b32 s63, 167936
    s_cselect_b32 s63, 81920, s63
    s_mov_b32 s64, 2624
    s_cselect_b32 s64, 1280, s64
    s_mov_b32 s57, 3968
    s_cselect_b32 s57, 1280, s57
    s_cselect_b32 s65, 0x00000000, 0x00280000
    s_cselect_b32 s67, 0, 5
    s_sub_u32 s67, s48, s67
    s_lshl_b32 s67, s67, 5
    s_lshl_b32 s69, s49, 4
    s_add_u32 s67, s67, s69
    s_mul_i32 s68, s68, s64
    s_add_u32 s65, s65, s68
    v_lshlrev_b32 v78, 3, v76
    v_add_u32 v78, s65, v78
    v_add_u32 v82, s67, v72
    v_add_u32 v83, 0, v82
    v_mul_u32_u24 v84, 205, v83
    v_lshrrev_b32 v84, 10, v84
    v_mad_i32_i24 v85, v84, -5, v83
    v_mad_u32_u24 v84, v84, s63, v78
    v_lshl_add_u32 v12, v85, 8, v84
    v_add_u32 v83, 4, v82
    v_mul_u32_u24 v84, 205, v83
    v_lshrrev_b32 v84, 10, v84
    v_mad_i32_i24 v85, v84, -5, v83
    v_mad_u32_u24 v84, v84, s63, v78
    v_lshl_add_u32 v13, v85, 8, v84
    v_add_u32 v83, 8, v82
    v_mul_u32_u24 v84, 205, v83
    v_lshrrev_b32 v84, 10, v84
    v_mad_i32_i24 v85, v84, -5, v83
    v_mad_u32_u24 v84, v84, s63, v78
    v_lshl_add_u32 v14, v85, 8, v84
    v_add_u32 v83, 12, v82
    v_mul_u32_u24 v84, 205, v83
    v_lshrrev_b32 v84, 10, v84
    v_mad_i32_i24 v85, v84, -5, v83
    v_mad_u32_u24 v84, v84, s63, v78
    v_lshl_add_u32 v15, v85, 8, v84
    s_branch K1_PRE_DONE
K1_PRE_V:
    s_sub_u32 s67, s48, 10
    s_lshl_b32 s67, s67, 7
    s_lshl_b32 s69, s49, 6
    s_add_u32 s67, s67, s69
    s_mul_i32 s68, s68, 2624
    s_add_u32 s68, s68, 0x00280500
    s_mov_b32 s63, 167936
    s_mov_b32 s64, -20
    s_lshl_b32 s65, s44, 13
    v_add_u32 v74, s67, v76
    v_lshlrev_b32 v73, 7, v76
    v_add_u32 v73, s65, v73
    v_add_u32 v77, 0, v74
    v_mul_u32_u24 v78, 3277, v77
    v_lshrrev_b32 v78, 16, v78
    v_mad_i32_i24 v79, v78, s64, v77
    v_bfe_u32 v79, v79, 1, 3
    v_xor_b32 v79, v79, v72
    v_lshl_add_u32 v8, v79, 4, v73
    v_add_u32 v77, 16, v74
    v_mul_u32_u24 v78, 3277, v77
    v_lshrrev_b32 v78, 16, v78
    v_mad_i32_i24 v79, v78, s64, v77
    v_bfe_u32 v79, v79, 1, 3
    v_xor_b32 v79, v79, v72
    v_lshl_add_u32 v9, v79, 4, v73
    v_add_u32 v77, 32, v74
    v_mul_u32_u24 v78, 3277, v77
    v_lshrrev_b32 v78, 16, v78
    v_mad_i32_i24 v79, v78, s64, v77
    v_bfe_u32 v79, v79, 1, 3
    v_xor_b32 v79, v79, v72
    v_lshl_add_u32 v10, v79, 4, v73
    v_add_u32 v77, 48, v74
    v_mul_u32_u24 v78, 3277, v77
    v_lshrrev_b32 v78, 16, v78
    v_mad_i32_i24 v79, v78, s64, v77
    v_bfe_u32 v79, v79, 1, 3
    v_xor_b32 v79, v79, v72
    v_lshl_add_u32 v11, v79, 4, v73
    v_lshrrev_b32 v74, 3, v1
    v_add_u32 v74, s67, v74
    v_and_b32 v73, 7, v1
    v_lshlrev_b32 v73, 4, v73
    v_add_u32 v73, s68, v73
    v_add_u32 v77, 0, v74
    v_mul_u32_u24 v78, 3277, v77
    v_lshrrev_b32 v78, 16, v78
    v_mad_i32_i24 v79, v78, s64, v77
    v_mad_u32_u24 v78, v78, s63, v73
    v_lshl_add_u32 v12, v79, 7, v78
    v_add_u32 v77, 8, v74
    v_mul_u32_u24 v78, 3277, v77
    v_lshrrev_b32 v78, 16, v78
    v_mad_i32_i24 v79, v78, s64, v77
    v_mad_u32_u24 v78, v78, s63, v73
    v_lshl_add_u32 v13, v79, 7, v78
    v_add_u32 v77, 16, v74
    v_mul_u32_u24 v78, 3277, v77
    v_lshrrev_b32 v78, 16, v78
    v_mad_i32_i24 v79, v78, s64, v77
    v_mad_u32_u24 v78, v78, s63, v73
    v_lshl_add_u32 v14, v79, 7, v78
    v_add_u32 v77, 24, v74
    v_mul_u32_u24 v78, 3277, v77
    v_lshrrev_b32 v78, 16, v78
    v_mad_i32_i24 v79, v78, s64, v77
    v_mad_u32_u24 v78, v78, s63, v73
    v_lshl_add_u32 v15, v79, 7, v78
    v_add_u32 v77, 32, v74
    v_mul_u32_u24 v78, 3277, v77
    v_lshrrev_b32 v78, 16, v78
    v_mad_i32_i24 v79, v78, s64, v77
    v_mad_u32_u24 v78, v78, s63, v73
    v_lshl_add_u32 v16, v79, 7, v78
    v_add_u32 v77, 40, v74
    v_mul_u32_u24 v78, 3277, v77
    v_lshrrev_b32 v78, 16, v78
    v_mad_i32_i24 v79, v78, s64, v77
    v_mad_u32_u24 v78, v78, s63, v73
    v_lshl_add_u32 v17, v79, 7, v78
    v_add_u32 v77, 48, v74
    v_mul_u32_u24 v78, 3277, v77
    v_lshrrev_b32 v78, 16, v78
    v_mad_i32_i24 v79, v78, s64, v77
    v_mad_u32_u24 v78, v78, s63, v73
    v_lshl_add_u32 v18, v79, 7, v78
    v_add_u32 v77, 56, v74
    v_mul_u32_u24 v78, 3277, v77
    v_lshrrev_b32 v78, 16, v78
    v_mad_i32_i24 v79, v78, s64, v77
    v_mad_u32_u24 v78, v78, s63, v73
    v_lshl_add_u32 v19, v79, 7, v78
    s_branch K1_PRE_DONE
K1_PRE_F:
    s_lshl_b32 s62, s48, 1
    s_add_u32 s62, s62, s49
    s_cmp_eq_u32 s62, 26
    s_cbranch_scc1 K1_PRE_DONE
    s_cmp_ge_u32 s62, 28
    s_cbranch_scc1 K1_PRE_DONE
    s_lshl_b32 s62, s68, 5
    v_add_u32 v12, s62, v76
    v_lshlrev_b32 v12, 4, v12
    v_lshl_add_u32 v12, v72, 15, v12
    s_lshl_b32 s62, s50, 16
    s_lshl_b32 s63, s49, 18
    s_add_u32 s62, s62, s63
    s_add_u32 s62, s62, 0x00a20000
    v_add_u32 v12, s62, v12
    v_add_u32 v13, 0x00020000, v12
K1_PRE_DONE:
    s_waitcnt lgkmcnt(0)
    s_mov_b32 s32, s18
    s_mov_b32 s33, s19
    s_mov_b32 s34, 0x013cb000
    s_mov_b32 s35, 0x00020000
    s_and_b32 s62, s73, 1
    s_lshl_b32 s62, s62, 1
    s_add_u32 s62, s62, s45
    s_cmp_eq_u32 s62, 1
    s_cbranch_scc1 K1_V1
    s_cmp_eq_u32 s62, 2
    s_cbranch_scc1 K1_V2
    s_cmp_eq_u32 s62, 3
    s_cbranch_scc1 K1_V3
.p2align 3
K1_V0:
    v_add_u32 v7, s56, v4
    v_add_u32 v5, s56, v2
    v_add_u32 v6, s56, v3
    s_add_u32 s56, s56, 50176
    s_cmp_eq_u32 s56, 150528
    s_cselect_b32 s56, 0, s56
    s_barrier
    ds_read_b64_tr_b16 v[56:57], v7 offset:0
    ds_read_b64_tr_b16 v[58:59], v7 offset:256
    ds_read_b128 v[40:43], v5 offset:0
    ds_read_b128 v[44:47], v5 offset:2048
    ds_read_b128 v[48:51], v5 offset:4096
    ds_read_b128 v[52:55], v5 offset:6144
    ds_read_b64_tr_b16 v[60:61], v7 offset:32
    ds_read_b64_tr_b16 v[62:63], v7 offset:288
    ds_read_b64_tr_b16 v[64:65], v7 offset:64
    ds_read_b64_tr_b16 v[66:67], v7 offset:320
    ds_read_b64_tr_b16 v[68:69], v7 offset:96
    ds_read_b64_tr_b16 v[70:71], v7 offset:352
.p2align 6
K1_L0:
    s_waitcnt lgkmcnt(0)
    ds_read_b64_tr_b16 v[88:89], v7 offset:8448
    v_mfma_f32_16x16x32_bf16 v[104:107], v[56:59], v[40:43], v[104:107]
    ds_read_b64_tr_b16 v[90:91], v7 offset:8704
    v_mfma_f32_16x16x32_bf16 v[108:111], v[56:59], v[44:47], v[108:111]
    ds_read_b128 v[72:75], v6 offset:0
    v_mfma_f32_16x16x32_bf16 v[112:115], v[56:59], v[48:51], v[112:115]
    ds_read_b128 v[76:79], v6 offset:2048
    v_mfma_f32_16x16x32_bf16 v[116:119], v[56:59], v[52:55], v[116:119]
    ds_read_b128 v[80:83], v6 offset:4096
    v_mfma_f32_16x16x32_bf16 v[24:27], v[56:59], v[20:23], v[24:27]
    ds_read_b128 v[84:87], v6 offset:6144
    v_mfma_f32_16x16x32_bf16 v[120:123], v[60:63], v[40:43], v[120:123]
    ds_read_b64_tr_b16 v[92:93], v7 offset:8480
    v_mfma_f32_16x16x32_bf16 v[124:127], v[60:63], v[44:47], v[124:127]
    ds_read_b64_tr_b16 v[94:95], v7 offset:8736
    v_mfma_f32_16x16x32_bf16 v[128:131], v[60:63], v[48:51], v[128:131]
    ds_read_b64_tr_b16 v[96:97], v7 offset:8512
    v_mfma_f32_16x16x32_bf16 v[132:135], v[60:63], v[52:55], v[132:135]
    ds_read_b64_tr_b16 v[98:99], v7 offset:8768
    v_mfma_f32_16x16x32_bf16 v[28:31], v[60:63], v[20:23], v[28:31]
    ds_read_b64_tr_b16 v[100:101], v7 offset:8544
    v_mfma_f32_16x16x32_bf16 v[136:139], v[64:67], v[40:43], v[136:139]
    ds_read_b64_tr_b16 v[102:103], v7 offset:8800
    v_mfma_f32_16x16x32_bf16 v[140:143], v[64:67], v[44:47], v[140:143]
    v_mfma_f32_16x16x32_bf16 v[144:147], v[64:67], v[48:51], v[144:147]
    v_mfma_f32_16x16x32_bf16 v[148:151], v[64:67], v[52:55], v[148:151]
    v_mfma_f32_16x16x32_bf16 v[152:155], v[68:71], v[40:43], v[152:155]
    v_mfma_f32_16x16x32_bf16 v[156:159], v[68:71], v[44:47], v[156:159]
    v_mfma_f32_16x16x32_bf16 v[160:163], v[68:71], v[48:51], v[160:163]
    v_mfma_f32_16x16x32_bf16 v[164:167], v[68:71], v[52:55], v[164:167]
    s_waitcnt lgkmcnt(0)
    v_mfma_f32_16x16x32_bf16 v[104:107], v[88:91], v[72:75], v[104:107]
    v_mfma_f32_16x16x32_bf16 v[108:111], v[88:91], v[76:79], v[108:111]
    v_add_u32 v7, s56, v4
    v_add_u32 v5, s56, v2
    v_add_u32 v6, s56, v3
    s_add_u32 s56, s56, 50176
    s_cmp_eq_u32 s56, 150528
    s_cselect_b32 s56, 0, s56
    s_barrier
    ds_read_b64_tr_b16 v[56:57], v7 offset:0
    v_mfma_f32_16x16x32_bf16 v[112:115], v[88:91], v[80:83], v[112:115]
    ds_read_b64_tr_b16 v[58:59], v7 offset:256
    v_mfma_f32_16x16x32_bf16 v[116:119], v[88:91], v[84:87], v[116:119]
    ds_read_b128 v[40:43], v5 offset:0
    v_mfma_f32_16x16x32_bf16 v[24:27], v[88:91], v[20:23], v[24:27]
    ds_read_b128 v[44:47], v5 offset:2048
    v_mfma_f32_16x16x32_bf16 v[120:123], v[92:95], v[72:75], v[120:123]
    ds_read_b128 v[48:51], v5 offset:4096
    v_mfma_f32_16x16x32_bf16 v[124:127], v[92:95], v[76:79], v[124:127]
    ds_read_b128 v[52:55], v5 offset:6144
    v_mfma_f32_16x16x32_bf16 v[128:131], v[92:95], v[80:83], v[128:131]
    ds_read_b64_tr_b16 v[60:61], v7 offset:32
    v_mfma_f32_16x16x32_bf16 v[132:135], v[92:95], v[84:87], v[132:135]
    ds_read_b64_tr_b16 v[62:63], v7 offset:288
    v_mfma_f32_16x16x32_bf16 v[28:31], v[92:95], v[20:23], v[28:31]
    ds_read_b64_tr_b16 v[64:65], v7 offset:64
    v_mfma_f32_16x16x32_bf16 v[136:139], v[96:99], v[72:75], v[136:139]
    ds_read_b64_tr_b16 v[66:67], v7 offset:320
    v_mfma_f32_16x16x32_bf16 v[140:143], v[96:99], v[76:79], v[140:143]
    ds_read_b64_tr_b16 v[68:69], v7 offset:96
    v_mfma_f32_16x16x32_bf16 v[144:147], v[96:99], v[80:83], v[144:147]
    ds_read_b64_tr_b16 v[70:71], v7 offset:352
    v_mfma_f32_16x16x32_bf16 v[148:151], v[96:99], v[84:87], v[148:151]
    v_mfma_f32_16x16x32_bf16 v[152:155], v[100:103], v[72:75], v[152:155]
    v_mfma_f32_16x16x32_bf16 v[156:159], v[100:103], v[76:79], v[156:159]
    v_mfma_f32_16x16x32_bf16 v[160:163], v[100:103], v[80:83], v[160:163]
    v_mfma_f32_16x16x32_bf16 v[164:167], v[100:103], v[84:87], v[164:167]
    s_add_u32 s58, s58, 1
    s_cmp_lt_u32 s58, 10
    s_cbranch_scc1 K1_L0
    s_branch K1_EPI
.p2align 3
K1_V1:
    v_add_u32 v7, s56, v4
    v_add_u32 v5, s56, v2
    v_add_u32 v6, s56, v3
    s_add_u32 s56, s56, 50176
    s_cmp_eq_u32 s56, 150528
    s_cselect_b32 s56, 0, s56
    s_barrier
    ds_read_b64_tr_b16 v[56:57], v7 offset:0
    ds_read_b64_tr_b16 v[58:59], v7 offset:256
    ds_read_b128 v[40:43], v5 offset:0
    ds_read_b128 v[44:47], v5 offset:2048
    ds_read_b128 v[48:51], v5 offset:4096
    ds_read_b128 v[52:55], v5 offset:6144
    ds_read_b64_tr_b16 v[60:61], v7 offset:32
    ds_read_b64_tr_b16 v[62:63], v7 offset:288
    ds_read_b64_tr_b16 v[64:65], v7 offset:64
    ds_read_b64_tr_b16 v[66:67], v7 offset:320
    ds_read_b64_tr_b16 v[68:69], v7 offset:96
    ds_read_b64_tr_b16 v[70:71], v7 offset:352
.p2align 6
K1_L1:
    s_waitcnt lgkmcnt(0)
    ds_read_b64_tr_b16 v[88:89], v7 offset:8448
    v_mfma_f32_16x16x32_bf16 v[104:107], v[56:59], v[40:43], v[104:107]
    ds_read_b64_tr_b16 v[90:91], v7 offset:8704
    v_mfma_f32_16x16x32_bf16 v[108:111], v[56:59], v[44:47], v[108:111]
    ds_read_b128 v[72:75], v6 offset:0
    v_mfma_f32_16x16x32_bf16 v[112:115], v[56:59], v[48:51], v[112:115]
    ds_read_b128 v[76:79], v6 offset:2048
    v_mfma_f32_16x16x32_bf16 v[116:119], v[56:59], v[52:55], v[116:119]
    ds_read_b128 v[80:83], v6 offset:4096
    v_mfma_f32_16x16x32_bf16 v[120:123], v[60:63], v[40:43], v[120:123]
    ds_read_b128 v[84:87], v6 offset:6144
    v_mfma_f32_16x16x32_bf16 v[124:127], v[60:63], v[44:47], v[124:127]
    ds_read_b64_tr_b16 v[92:93], v7 offset:8480
    v_mfma_f32_16x16x32_bf16 v[128:131], v[60:63], v[48:51], v[128:131]
    ds_read_b64_tr_b16 v[94:95], v7 offset:8736
    v_mfma_f32_16x16x32_bf16 v[132:135], v[60:63], v[52:55], v[132:135]
    ds_read_b64_tr_b16 v[96:97], v7 offset:8512
    v_mfma_f32_16x16x32_bf16 v[136:139], v[64:67], v[40:43], v[136:139]
    ds_read_b64_tr_b16 v[98:99], v7 offset:8768
    v_mfma_f32_16x16x32_bf16 v[140:143], v[64:67], v[44:47], v[140:143]
    ds_read_b64_tr_b16 v[100:101], v7 offset:8544
    v_mfma_f32_16x16x32_bf16 v[144:147], v[64:67], v[48:51], v[144:147]
    ds_read_b64_tr_b16 v[102:103], v7 offset:8800
    v_mfma_f32_16x16x32_bf16 v[148:151], v[64:67], v[52:55], v[148:151]
    v_mfma_f32_16x16x32_bf16 v[24:27], v[64:67], v[20:23], v[24:27]
    v_mfma_f32_16x16x32_bf16 v[152:155], v[68:71], v[40:43], v[152:155]
    v_mfma_f32_16x16x32_bf16 v[156:159], v[68:71], v[44:47], v[156:159]
    v_mfma_f32_16x16x32_bf16 v[160:163], v[68:71], v[48:51], v[160:163]
    v_mfma_f32_16x16x32_bf16 v[164:167], v[68:71], v[52:55], v[164:167]
    v_mfma_f32_16x16x32_bf16 v[28:31], v[68:71], v[20:23], v[28:31]
    s_waitcnt lgkmcnt(0)
    v_mfma_f32_16x16x32_bf16 v[104:107], v[88:91], v[72:75], v[104:107]
    v_mfma_f32_16x16x32_bf16 v[108:111], v[88:91], v[76:79], v[108:111]
    v_add_u32 v7, s56, v4
    v_add_u32 v5, s56, v2
    v_add_u32 v6, s56, v3
    s_add_u32 s56, s56, 50176
    s_cmp_eq_u32 s56, 150528
    s_cselect_b32 s56, 0, s56
    s_barrier
    ds_read_b64_tr_b16 v[56:57], v7 offset:0
    v_mfma_f32_16x16x32_bf16 v[112:115], v[88:91], v[80:83], v[112:115]
    ds_read_b64_tr_b16 v[58:59], v7 offset:256
    v_mfma_f32_16x16x32_bf16 v[116:119], v[88:91], v[84:87], v[116:119]
    ds_read_b128 v[40:43], v5 offset:0
    v_mfma_f32_16x16x32_bf16 v[120:123], v[92:95], v[72:75], v[120:123]
    ds_read_b128 v[44:47], v5 offset:2048
    v_mfma_f32_16x16x32_bf16 v[124:127], v[92:95], v[76:79], v[124:127]
    ds_read_b128 v[48:51], v5 offset:4096
    v_mfma_f32_16x16x32_bf16 v[128:131], v[92:95], v[80:83], v[128:131]
    ds_read_b128 v[52:55], v5 offset:6144
    v_mfma_f32_16x16x32_bf16 v[132:135], v[92:95], v[84:87], v[132:135]
    ds_read_b64_tr_b16 v[60:61], v7 offset:32
    v_mfma_f32_16x16x32_bf16 v[136:139], v[96:99], v[72:75], v[136:139]
    ds_read_b64_tr_b16 v[62:63], v7 offset:288
    v_mfma_f32_16x16x32_bf16 v[140:143], v[96:99], v[76:79], v[140:143]
    ds_read_b64_tr_b16 v[64:65], v7 offset:64
    v_mfma_f32_16x16x32_bf16 v[144:147], v[96:99], v[80:83], v[144:147]
    ds_read_b64_tr_b16 v[66:67], v7 offset:320
    v_mfma_f32_16x16x32_bf16 v[148:151], v[96:99], v[84:87], v[148:151]
    ds_read_b64_tr_b16 v[68:69], v7 offset:96
    v_mfma_f32_16x16x32_bf16 v[24:27], v[96:99], v[20:23], v[24:27]
    ds_read_b64_tr_b16 v[70:71], v7 offset:352
    v_mfma_f32_16x16x32_bf16 v[152:155], v[100:103], v[72:75], v[152:155]
    v_mfma_f32_16x16x32_bf16 v[156:159], v[100:103], v[76:79], v[156:159]
    v_mfma_f32_16x16x32_bf16 v[160:163], v[100:103], v[80:83], v[160:163]
    v_mfma_f32_16x16x32_bf16 v[164:167], v[100:103], v[84:87], v[164:167]
    v_mfma_f32_16x16x32_bf16 v[28:31], v[100:103], v[20:23], v[28:31]
    s_add_u32 s58, s58, 1
    s_cmp_lt_u32 s58, 10
    s_cbranch_scc1 K1_L1
    s_branch K1_EPI
.p2align 3
K1_V2:
    v_add_u32 v7, s56, v4
    v_add_u32 v5, s56, v2
    v_add_u32 v6, s56, v3
    s_add_u32 s56, s56, 50176
    s_cmp_eq_u32 s56, 150528
    s_cselect_b32 s56, 0, s56
    s_barrier
    ds_read_b64_tr_b16 v[56:57], v7 offset:0
    ds_read_b64_tr_b16 v[58:59], v7 offset:256
    ds_read_b128 v[40:43], v5 offset:0
    ds_read_b128 v[44:47], v5 offset:2048
    ds_read_b128 v[48:51], v5 offset:4096
    ds_read_b128 v[52:55], v5 offset:6144
    ds_read_b64_tr_b16 v[60:61], v7 offset:32
    ds_read_b64_tr_b16 v[62:63], v7 offset:288
    ds_read_b64_tr_b16 v[64:65], v7 offset:64
    ds_read_b64_tr_b16 v[66:67], v7 offset:320
    ds_read_b64_tr_b16 v[68:69], v7 offset:96
    ds_read_b64_tr_b16 v[70:71], v7 offset:352
.p2align 6
K1_L2:
    s_waitcnt lgkmcnt(0)
    ds_read_b64_tr_b16 v[88:89], v7 offset:8448
    v_mfma_f32_16x16x32_bf16 v[104:107], v[40:43], v[56:59], v[104:107]
    ds_read_b64_tr_b16 v[90:91], v7 offset:8704
    v_mfma_f32_16x16x32_bf16 v[108:111], v[44:47], v[56:59], v[108:111]
    ds_read_b128 v[72:75], v6 offset:0
    v_mfma_f32_16x16x32_bf16 v[112:115], v[48:51], v[56:59], v[112:115]
    ds_read_b128 v[76:79], v6 offset:2048
    v_mfma_f32_16x16x32_bf16 v[116:119], v[52:55], v[56:59], v[116:119]
    ds_read_b128 v[80:83], v6 offset:4096
    v_mfma_f32_16x16x32_bf16 v[24:27], v[56:59], v[20:23], v[24:27]
    ds_read_b128 v[84:87], v6 offset:6144
    v_mfma_f32_16x16x32_bf16 v[120:123], v[40:43], v[60:63], v[120:123]
    ds_read_b64_tr_b16 v[92:93], v7 offset:8480
    v_mfma_f32_16x16x32_bf16 v[124:127], v[44:47], v[60:63], v[124:127]
    ds_read_b64_tr_b16 v[94:95], v7 offset:8736
    v_mfma_f32_16x16x32_bf16 v[128:131], v[48:51], v[60:63], v[128:131]
    ds_read_b64_tr_b16 v[96:97], v7 offset:8512
    v_mfma_f32_16x16x32_bf16 v[132:135], v[52:55], v[60:63], v[132:135]
    ds_read_b64_tr_b16 v[98:99], v7 offset:8768
    v_mfma_f32_16x16x32_bf16 v[28:31], v[60:63], v[20:23], v[28:31]
    ds_read_b64_tr_b16 v[100:101], v7 offset:8544
    v_mfma_f32_16x16x32_bf16 v[136:139], v[40:43], v[64:67], v[136:139]
    ds_read_b64_tr_b16 v[102:103], v7 offset:8800
    v_mfma_f32_16x16x32_bf16 v[140:143], v[44:47], v[64:67], v[140:143]
    v_mfma_f32_16x16x32_bf16 v[144:147], v[48:51], v[64:67], v[144:147]
    v_mfma_f32_16x16x32_bf16 v[148:151], v[52:55], v[64:67], v[148:151]
    v_mfma_f32_16x16x32_bf16 v[152:155], v[40:43], v[68:71], v[152:155]
    v_mfma_f32_16x16x32_bf16 v[156:159], v[44:47], v[68:71], v[156:159]
    v_mfma_f32_16x16x32_bf16 v[160:163], v[48:51], v[68:71], v[160:163]
    v_mfma_f32_16x16x32_bf16 v[164:167], v[52:55], v[68:71], v[164:167]
    s_waitcnt lgkmcnt(0)
    v_mfma_f32_16x16x32_bf16 v[104:107], v[72:75], v[88:91], v[104:107]
    v_mfma_f32_16x16x32_bf16 v[108:111], v[76:79], v[88:91], v[108:111]
    v_add_u32 v7, s56, v4
    v_add_u32 v5, s56, v2
    v_add_u32 v6, s56, v3
    s_add_u32 s56, s56, 50176
    s_cmp_eq_u32 s56, 150528
    s_cselect_b32 s56, 0, s56
    s_barrier
    ds_read_b64_tr_b16 v[56:57], v7 offset:0
    v_mfma_f32_16x16x32_bf16 v[112:115], v[80:83], v[88:91], v[112:115]
    ds_read_b64_tr_b16 v[58:59], v7 offset:256
    v_mfma_f32_16x16x32_bf16 v[116:119], v[84:87], v[88:91], v[116:119]
    ds_read_b128 v[40:43], v5 offset:0
    v_mfma_f32_16x16x32_bf16 v[24:27], v[88:91], v[20:23], v[24:27]
    ds_read_b128 v[44:47], v5 offset:2048
    v_mfma_f32_16x16x32_bf16 v[120:123], v[72:75], v[92:95], v[120:123]
    ds_read_b128 v[48:51], v5 offset:4096
    v_mfma_f32_16x16x32_bf16 v[124:127], v[76:79], v[92:95], v[124:127]
    ds_read_b128 v[52:55], v5 offset:6144
    v_mfma_f32_16x16x32_bf16 v[128:131], v[80:83], v[92:95], v[128:131]
    ds_read_b64_tr_b16 v[60:61], v7 offset:32
    v_mfma_f32_16x16x32_bf16 v[132:135], v[84:87], v[92:95], v[132:135]
    ds_read_b64_tr_b16 v[62:63], v7 offset:288
    v_mfma_f32_16x16x32_bf16 v[28:31], v[92:95], v[20:23], v[28:31]
    ds_read_b64_tr_b16 v[64:65], v7 offset:64
    v_mfma_f32_16x16x32_bf16 v[136:139], v[72:75], v[96:99], v[136:139]
    ds_read_b64_tr_b16 v[66:67], v7 offset:320
    v_mfma_f32_16x16x32_bf16 v[140:143], v[76:79], v[96:99], v[140:143]
    ds_read_b64_tr_b16 v[68:69], v7 offset:96
    v_mfma_f32_16x16x32_bf16 v[144:147], v[80:83], v[96:99], v[144:147]
    ds_read_b64_tr_b16 v[70:71], v7 offset:352
    v_mfma_f32_16x16x32_bf16 v[148:151], v[84:87], v[96:99], v[148:151]
    v_mfma_f32_16x16x32_bf16 v[152:155], v[72:75], v[100:103], v[152:155]
    v_mfma_f32_16x16x32_bf16 v[156:159], v[76:79], v[100:103], v[156:159]
    v_mfma_f32_16x16x32_bf16 v[160:163], v[80:83], v[100:103], v[160:163]
    v_mfma_f32_16x16x32_bf16 v[164:167], v[84:87], v[100:103], v[164:167]
    s_add_u32 s58, s58, 1
    s_cmp_lt_u32 s58, 10
    s_cbranch_scc1 K1_L2
    s_branch K1_EPI
.p2align 3
K1_V3:
    v_add_u32 v7, s56, v4
    v_add_u32 v5, s56, v2
    v_add_u32 v6, s56, v3
    s_add_u32 s56, s56, 50176
    s_cmp_eq_u32 s56, 150528
    s_cselect_b32 s56, 0, s56
    s_barrier
    ds_read_b64_tr_b16 v[56:57], v7 offset:0
    ds_read_b64_tr_b16 v[58:59], v7 offset:256
    ds_read_b128 v[40:43], v5 offset:0
    ds_read_b128 v[44:47], v5 offset:2048
    ds_read_b128 v[48:51], v5 offset:4096
    ds_read_b128 v[52:55], v5 offset:6144
    ds_read_b64_tr_b16 v[60:61], v7 offset:32
    ds_read_b64_tr_b16 v[62:63], v7 offset:288
    ds_read_b64_tr_b16 v[64:65], v7 offset:64
    ds_read_b64_tr_b16 v[66:67], v7 offset:320
    ds_read_b64_tr_b16 v[68:69], v7 offset:96
    ds_read_b64_tr_b16 v[70:71], v7 offset:352
.p2align 6
K1_L3:
    s_waitcnt lgkmcnt(0)
    ds_read_b64_tr_b16 v[88:89], v7 offset:8448
    v_mfma_f32_16x16x32_bf16 v[104:107], v[40:43], v[56:59], v[104:107]
    ds_read_b64_tr_b16 v[90:91], v7 offset:8704
    v_mfma_f32_16x16x32_bf16 v[108:111], v[44:47], v[56:59], v[108:111]
    ds_read_b128 v[72:75], v6 offset:0
    v_mfma_f32_16x16x32_bf16 v[112:115], v[48:51], v[56:59], v[112:115]
    ds_read_b128 v[76:79], v6 offset:2048
    v_mfma_f32_16x16x32_bf16 v[116:119], v[52:55], v[56:59], v[116:119]
    ds_read_b128 v[80:83], v6 offset:4096
    v_mfma_f32_16x16x32_bf16 v[120:123], v[40:43], v[60:63], v[120:123]
    ds_read_b128 v[84:87], v6 offset:6144
    v_mfma_f32_16x16x32_bf16 v[124:127], v[44:47], v[60:63], v[124:127]
    ds_read_b64_tr_b16 v[92:93], v7 offset:8480
    v_mfma_f32_16x16x32_bf16 v[128:131], v[48:51], v[60:63], v[128:131]
    ds_read_b64_tr_b16 v[94:95], v7 offset:8736
    v_mfma_f32_16x16x32_bf16 v[132:135], v[52:55], v[60:63], v[132:135]
    ds_read_b64_tr_b16 v[96:97], v7 offset:8512
    v_mfma_f32_16x16x32_bf16 v[136:139], v[40:43], v[64:67], v[136:139]
    ds_read_b64_tr_b16 v[98:99], v7 offset:8768
    v_mfma_f32_16x16x32_bf16 v[140:143], v[44:47], v[64:67], v[140:143]
    ds_read_b64_tr_b16 v[100:101], v7 offset:8544
    v_mfma_f32_16x16x32_bf16 v[144:147], v[48:51], v[64:67], v[144:147]
    ds_read_b64_tr_b16 v[102:103], v7 offset:8800
    v_mfma_f32_16x16x32_bf16 v[148:151], v[52:55], v[64:67], v[148:151]
    v_mfma_f32_16x16x32_bf16 v[24:27], v[64:67], v[20:23], v[24:27]
    v_mfma_f32_16x16x32_bf16 v[152:155], v[40:43], v[68:71], v[152:155]
    v_mfma_f32_16x16x32_bf16 v[156:159], v[44:47], v[68:71], v[156:159]
    v_mfma_f32_16x16x32_bf16 v[160:163], v[48:51], v[68:71], v[160:163]
    v_mfma_f32_16x16x32_bf16 v[164:167], v[52:55], v[68:71], v[164:167]
    v_mfma_f32_16x16x32_bf16 v[28:31], v[68:71], v[20:23], v[28:31]
    s_waitcnt lgkmcnt(0)
    v_mfma_f32_16x16x32_bf16 v[104:107], v[72:75], v[88:91], v[104:107]
    v_mfma_f32_16x16x32_bf16 v[108:111], v[76:79], v[88:91], v[108:111]
    v_add_u32 v7, s56, v4
    v_add_u32 v5, s56, v2
    v_add_u32 v6, s56, v3
    s_add_u32 s56, s56, 50176
    s_cmp_eq_u32 s56, 150528
    s_cselect_b32 s56, 0, s56
    s_barrier
    ds_read_b64_tr_b16 v[56:57], v7 offset:0
    v_mfma_f32_16x16x32_bf16 v[112:115], v[80:83], v[88:91], v[112:115]
    ds_read_b64_tr_b16 v[58:59], v7 offset:256
    v_mfma_f32_16x16x32_bf16 v[116:119], v[84:87], v[88:91], v[116:119]
    ds_read_b128 v[40:43], v5 offset:0
    v_mfma_f32_16x16x32_bf16 v[120:123], v[72:75], v[92:95], v[120:123]
    ds_read_b128 v[44:47], v5 offset:2048
    v_mfma_f32_16x16x32_bf16 v[124:127], v[76:79], v[92:95], v[124:127]
    ds_read_b128 v[48:51], v5 offset:4096
    v_mfma_f32_16x16x32_bf16 v[128:131], v[80:83], v[92:95], v[128:131]
    ds_read_b128 v[52:55], v5 offset:6144
    v_mfma_f32_16x16x32_bf16 v[132:135], v[84:87], v[92:95], v[132:135]
    ds_read_b64_tr_b16 v[60:61], v7 offset:32
    v_mfma_f32_16x16x32_bf16 v[136:139], v[72:75], v[96:99], v[136:139]
    ds_read_b64_tr_b16 v[62:63], v7 offset:288
    v_mfma_f32_16x16x32_bf16 v[140:143], v[76:79], v[96:99], v[140:143]
    ds_read_b64_tr_b16 v[64:65], v7 offset:64
    v_mfma_f32_16x16x32_bf16 v[144:147], v[80:83], v[96:99], v[144:147]
    ds_read_b64_tr_b16 v[66:67], v7 offset:320
    v_mfma_f32_16x16x32_bf16 v[148:151], v[84:87], v[96:99], v[148:151]
    ds_read_b64_tr_b16 v[68:69], v7 offset:96
    v_mfma_f32_16x16x32_bf16 v[24:27], v[96:99], v[20:23], v[24:27]
    ds_read_b64_tr_b16 v[70:71], v7 offset:352
    v_mfma_f32_16x16x32_bf16 v[152:155], v[72:75], v[100:103], v[152:155]
    v_mfma_f32_16x16x32_bf16 v[156:159], v[76:79], v[100:103], v[156:159]
    v_mfma_f32_16x16x32_bf16 v[160:163], v[80:83], v[100:103], v[160:163]
    v_mfma_f32_16x16x32_bf16 v[164:167], v[84:87], v[100:103], v[164:167]
    v_mfma_f32_16x16x32_bf16 v[28:31], v[100:103], v[20:23], v[28:31]
    s_add_u32 s58, s58, 1
    s_cmp_lt_u32 s58, 10
    s_cbranch_scc1 K1_L3
    s_branch K1_EPI
.p2align 3
K1_EPI:
    s_waitcnt vmcnt(0)
    v_and_b32 v72, 15, v1
    v_lshlrev_b32 v72, 2, v72
    s_lshl_b32 s62, s46, 7
    s_lshl_b32 s63, s49, 6
    s_add_u32 s62, s62, s63
    s_lshl_b32 s64, s45, 8
    s_add_u32 s64, s64, 150528
    s_add_u32 s62, s62, s64
    v_add_u32 v73, s62, v72
    v_lshrrev_b32 v74, 4, v1
    v_lshlrev_b32 v74, 4, v74
    s_lshl_b32 s65, s46, 9
    s_lshl_b32 s63, s49, 8
    s_add_u32 s65, s65, s63
    s_add_u32 s65, s65, 151552
    s_lshl_b32 s63, s45, 7
    s_add_u32 s62, s65, s63
    v_add_u32 v75, s62, v74
    s_mov_b32 exec_lo, 0x00010001
    s_mov_b32 exec_hi, 0x00010001
    ds_write_b128 v75, v[24:27]
    ds_write_b128 v75, v[28:31] offset:64
    s_mov_b64 exec, -1
    s_waitcnt lgkmcnt(0)
    s_barrier
    s_cmp_eq_u32 s73, 1
    s_cbranch_scc1 K1_EPI_V
    v_add_u32 v72, s64, v72
    ds_read2_b32 v[32:33], v72 offset0:0 offset1:16
    ds_read2_b32 v[34:35], v72 offset0:32 offset1:48
    ds_read2_b32 v[36:37], v72 offset0:128 offset1:144
    ds_read2_b32 v[38:39], v72 offset0:160 offset1:176
    v_add_u32 v73, s65, v74
    ds_read_b128 v[40:43], v73 offset:0
    ds_read_b128 v[44:47], v73 offset:64
    ds_read_b128 v[48:51], v73 offset:128
    ds_read_b128 v[52:55], v73 offset:192
    s_cmp_eq_u32 s73, 2
    s_cbranch_scc1 K1_EPI_F
    s_cmp_lt_u32 s48, 5
    s_cselect_b32 s62, 0x3ea52b5c, 1.0
    s_waitcnt lgkmcnt(4)
    v_mul_f32 v36, s62, v36
    v_mul_f32 v37, s62, v37
    v_mul_f32 v38, s62, v38
    v_mul_f32 v39, s62, v39
    s_waitcnt lgkmcnt(3)
    v_pk_fma_f32 v[104:105], v[40:41], v[32:33], v[104:105] op_sel:[0,0,0] op_sel_hi:[1,0,1]
    v_pk_fma_f32 v[106:107], v[42:43], v[32:33], v[106:107] op_sel:[0,0,0] op_sel_hi:[1,0,1]
    v_pk_fma_f32 v[108:109], v[40:41], v[32:33], v[108:109] op_sel:[0,1,0] op_sel_hi:[1,1,1]
    v_pk_fma_f32 v[110:111], v[42:43], v[32:33], v[110:111] op_sel:[0,1,0] op_sel_hi:[1,1,1]
    v_pk_fma_f32 v[112:113], v[40:41], v[34:35], v[112:113] op_sel:[0,0,0] op_sel_hi:[1,0,1]
    v_pk_fma_f32 v[114:115], v[42:43], v[34:35], v[114:115] op_sel:[0,0,0] op_sel_hi:[1,0,1]
    v_pk_fma_f32 v[116:117], v[40:41], v[34:35], v[116:117] op_sel:[0,1,0] op_sel_hi:[1,1,1]
    v_pk_fma_f32 v[118:119], v[42:43], v[34:35], v[118:119] op_sel:[0,1,0] op_sel_hi:[1,1,1]
    v_pk_mul_f32 v[104:105], v[104:105], v[36:37] op_sel:[0,0] op_sel_hi:[1,0]
    v_pk_mul_f32 v[106:107], v[106:107], v[36:37] op_sel:[0,0] op_sel_hi:[1,0]
    v_pk_mul_f32 v[108:109], v[108:109], v[36:37] op_sel:[0,1] op_sel_hi:[1,1]
    v_pk_mul_f32 v[110:111], v[110:111], v[36:37] op_sel:[0,1] op_sel_hi:[1,1]
    v_pk_mul_f32 v[112:113], v[112:113], v[38:39] op_sel:[0,0] op_sel_hi:[1,0]
    v_pk_mul_f32 v[114:115], v[114:115], v[38:39] op_sel:[0,0] op_sel_hi:[1,0]
    v_pk_mul_f32 v[116:117], v[116:117], v[38:39] op_sel:[0,1] op_sel_hi:[1,1]
    v_pk_mul_f32 v[118:119], v[118:119], v[38:39] op_sel:[0,1] op_sel_hi:[1,1]
    v_cvt_pk_bf16_f32 v104, v104, v105
    v_cvt_pk_bf16_f32 v105, v106, v107
    buffer_store_dwordx2 v[104:105], v12, s[32:35], 0 offen offset:0 sc1
    v_cvt_pk_bf16_f32 v108, v108, v109
    v_cvt_pk_bf16_f32 v109, v110, v111
    buffer_store_dwordx2 v[108:109], v12, s[32:35], 0 offen offset:128 sc1
    v_cvt_pk_bf16_f32 v112, v112, v113
    v_cvt_pk_bf16_f32 v113, v114, v115
    buffer_store_dwordx2 v[112:113], v12, s[32:35], s57 offen offset:0 sc1
    v_cvt_pk_bf16_f32 v116, v116, v117
    v_cvt_pk_bf16_f32 v117, v118, v119
    buffer_store_dwordx2 v[116:117], v12, s[32:35], s57 offen offset:128 sc1
    s_waitcnt lgkmcnt(2)
    v_pk_fma_f32 v[120:121], v[44:45], v[32:33], v[120:121] op_sel:[0,0,0] op_sel_hi:[1,0,1]
    v_pk_fma_f32 v[122:123], v[46:47], v[32:33], v[122:123] op_sel:[0,0,0] op_sel_hi:[1,0,1]
    v_pk_fma_f32 v[124:125], v[44:45], v[32:33], v[124:125] op_sel:[0,1,0] op_sel_hi:[1,1,1]
    v_pk_fma_f32 v[126:127], v[46:47], v[32:33], v[126:127] op_sel:[0,1,0] op_sel_hi:[1,1,1]
    v_pk_fma_f32 v[128:129], v[44:45], v[34:35], v[128:129] op_sel:[0,0,0] op_sel_hi:[1,0,1]
    v_pk_fma_f32 v[130:131], v[46:47], v[34:35], v[130:131] op_sel:[0,0,0] op_sel_hi:[1,0,1]
    v_pk_fma_f32 v[132:133], v[44:45], v[34:35], v[132:133] op_sel:[0,1,0] op_sel_hi:[1,1,1]
    v_pk_fma_f32 v[134:135], v[46:47], v[34:35], v[134:135] op_sel:[0,1,0] op_sel_hi:[1,1,1]
    v_pk_mul_f32 v[120:121], v[120:121], v[36:37] op_sel:[0,0] op_sel_hi:[1,0]
    v_pk_mul_f32 v[122:123], v[122:123], v[36:37] op_sel:[0,0] op_sel_hi:[1,0]
    v_pk_mul_f32 v[124:125], v[124:125], v[36:37] op_sel:[0,1] op_sel_hi:[1,1]
    v_pk_mul_f32 v[126:127], v[126:127], v[36:37] op_sel:[0,1] op_sel_hi:[1,1]
    v_pk_mul_f32 v[128:129], v[128:129], v[38:39] op_sel:[0,0] op_sel_hi:[1,0]
    v_pk_mul_f32 v[130:131], v[130:131], v[38:39] op_sel:[0,0] op_sel_hi:[1,0]
    v_pk_mul_f32 v[132:133], v[132:133], v[38:39] op_sel:[0,1] op_sel_hi:[1,1]
    v_pk_mul_f32 v[134:135], v[134:135], v[38:39] op_sel:[0,1] op_sel_hi:[1,1]
    v_cvt_pk_bf16_f32 v120, v120, v121
    v_cvt_pk_bf16_f32 v121, v122, v123
    buffer_store_dwordx2 v[120:121], v13, s[32:35], 0 offen offset:0 sc1
    v_cvt_pk_bf16_f32 v124, v124, v125
    v_cvt_pk_bf16_f32 v125, v126, v127
    buffer_store_dwordx2 v[124:125], v13, s[32:35], 0 offen offset:128 sc1
    v_cvt_pk_bf16_f32 v128, v128, v129
    v_cvt_pk_bf16_f32 v129, v130, v131
    buffer_store_dwordx2 v[128:129], v13, s[32:35], s57 offen offset:0 sc1
    v_cvt_pk_bf16_f32 v132, v132, v133
    v_cvt_pk_bf16_f32 v133, v134, v135
    buffer_store_dwordx2 v[132:133], v13, s[32:35], s57 offen offset:128 sc1
    s_waitcnt lgkmcnt(1)
    v_pk_fma_f32 v[136:137], v[48:49], v[32:33], v[136:137] op_sel:[0,0,0] op_sel_hi:[1,0,1]
    v_pk_fma_f32 v[138:139], v[50:51], v[32:33], v[138:139] op_sel:[0,0,0] op_sel_hi:[1,0,1]
    v_pk_fma_f32 v[140:141], v[48:49], v[32:33], v[140:141] op_sel:[0,1,0] op_sel_hi:[1,1,1]
    v_pk_fma_f32 v[142:143], v[50:51], v[32:33], v[142:143] op_sel:[0,1,0] op_sel_hi:[1,1,1]
    v_pk_fma_f32 v[144:145], v[48:49], v[34:35], v[144:145] op_sel:[0,0,0] op_sel_hi:[1,0,1]
    v_pk_fma_f32 v[146:147], v[50:51], v[34:35], v[146:147] op_sel:[0,0,0] op_sel_hi:[1,0,1]
    v_pk_fma_f32 v[148:149], v[48:49], v[34:35], v[148:149] op_sel:[0,1,0] op_sel_hi:[1,1,1]
    v_pk_fma_f32 v[150:151], v[50:51], v[34:35], v[150:151] op_sel:[0,1,0] op_sel_hi:[1,1,1]
    v_pk_mul_f32 v[136:137], v[136:137], v[36:37] op_sel:[0,0] op_sel_hi:[1,0]
    v_pk_mul_f32 v[138:139], v[138:139], v[36:37] op_sel:[0,0] op_sel_hi:[1,0]
    v_pk_mul_f32 v[140:141], v[140:141], v[36:37] op_sel:[0,1] op_sel_hi:[1,1]
    v_pk_mul_f32 v[142:143], v[142:143], v[36:37] op_sel:[0,1] op_sel_hi:[1,1]
    v_pk_mul_f32 v[144:145], v[144:145], v[38:39] op_sel:[0,0] op_sel_hi:[1,0]
    v_pk_mul_f32 v[146:147], v[146:147], v[38:39] op_sel:[0,0] op_sel_hi:[1,0]
    v_pk_mul_f32 v[148:149], v[148:149], v[38:39] op_sel:[0,1] op_sel_hi:[1,1]
    v_pk_mul_f32 v[150:151], v[150:151], v[38:39] op_sel:[0,1] op_sel_hi:[1,1]
    v_cvt_pk_bf16_f32 v136, v136, v137
    v_cvt_pk_bf16_f32 v137, v138, v139
    buffer_store_dwordx2 v[136:137], v14, s[32:35], 0 offen offset:0 sc1
    v_cvt_pk_bf16_f32 v140, v140, v141
    v_cvt_pk_bf16_f32 v141, v142, v143
    buffer_store_dwordx2 v[140:141], v14, s[32:35], 0 offen offset:128 sc1
    v_cvt_pk_bf16_f32 v144, v144, v145
    v_cvt_pk_bf16_f32 v145, v146, v147
    buffer_store_dwordx2 v[144:145], v14, s[32:35], s57 offen offset:0 sc1
    v_cvt_pk_bf16_f32 v148, v148, v149
    v_cvt_pk_bf16_f32 v149, v150, v151
    buffer_store_dwordx2 v[148:149], v14, s[32:35], s57 offen offset:128 sc1
    s_waitcnt lgkmcnt(0)
    v_pk_fma_f32 v[152:153], v[52:53], v[32:33], v[152:153] op_sel:[0,0,0] op_sel_hi:[1,0,1]
    v_pk_fma_f32 v[154:155], v[54:55], v[32:33], v[154:155] op_sel:[0,0,0] op_sel_hi:[1,0,1]
    v_pk_fma_f32 v[156:157], v[52:53], v[32:33], v[156:157] op_sel:[0,1,0] op_sel_hi:[1,1,1]
    v_pk_fma_f32 v[158:159], v[54:55], v[32:33], v[158:159] op_sel:[0,1,0] op_sel_hi:[1,1,1]
    v_pk_fma_f32 v[160:161], v[52:53], v[34:35], v[160:161] op_sel:[0,0,0] op_sel_hi:[1,0,1]
    v_pk_fma_f32 v[162:163], v[54:55], v[34:35], v[162:163] op_sel:[0,0,0] op_sel_hi:[1,0,1]
    v_pk_fma_f32 v[164:165], v[52:53], v[34:35], v[164:165] op_sel:[0,1,0] op_sel_hi:[1,1,1]
    v_pk_fma_f32 v[166:167], v[54:55], v[34:35], v[166:167] op_sel:[0,1,0] op_sel_hi:[1,1,1]
    v_pk_mul_f32 v[152:153], v[152:153], v[36:37] op_sel:[0,0] op_sel_hi:[1,0]
    v_pk_mul_f32 v[154:155], v[154:155], v[36:37] op_sel:[0,0] op_sel_hi:[1,0]
    v_pk_mul_f32 v[156:157], v[156:157], v[36:37] op_sel:[0,1] op_sel_hi:[1,1]
    v_pk_mul_f32 v[158:159], v[158:159], v[36:37] op_sel:[0,1] op_sel_hi:[1,1]
    v_pk_mul_f32 v[160:161], v[160:161], v[38:39] op_sel:[0,0] op_sel_hi:[1,0]
    v_pk_mul_f32 v[162:163], v[162:163], v[38:39] op_sel:[0,0] op_sel_hi:[1,0]
    v_pk_mul_f32 v[164:165], v[164:165], v[38:39] op_sel:[0,1] op_sel_hi:[1,1]
    v_pk_mul_f32 v[166:167], v[166:167], v[38:39] op_sel:[0,1] op_sel_hi:[1,1]
    v_cvt_pk_bf16_f32 v152, v152, v153
    v_cvt_pk_bf16_f32 v153, v154, v155
    buffer_store_dwordx2 v[152:153], v15, s[32:35], 0 offen offset:0 sc1
    v_cvt_pk_bf16_f32 v156, v156, v157
    v_cvt_pk_bf16_f32 v157, v158, v159
    buffer_store_dwordx2 v[156:157], v15, s[32:35], 0 offen offset:128 sc1
    v_cvt_pk_bf16_f32 v160, v160, v161
    v_cvt_pk_bf16_f32 v161, v162, v163
    buffer_store_dwordx2 v[160:161], v15, s[32:35], s57 offen offset:0 sc1
    v_cvt_pk_bf16_f32 v164, v164, v165
    v_cvt_pk_bf16_f32 v165, v166, v167
    buffer_store_dwordx2 v[164:165], v15, s[32:35], s57 offen offset:128 sc1
    s_branch K1_SIGQ
K1_EPI_F:
    v_lshrrev_b32 v74, 1, v74
    s_lshl_b32 s62, s49, 7
    s_add_u32 s62, s62, 152576
    v_add_u32 v74, s62, v74
    ds_read_b64 v[56:57], v74 offset:0
    ds_read_b64 v[58:59], v74 offset:32
    ds_read_b64 v[60:61], v74 offset:64
    ds_read_b64 v[62:63], v74 offset:96
    v_mov_b32 v64, 0xc0135761
    v_mov_b32 v65, 0xc0135761
    v_mov_b32 v66, 1.0
    v_mov_b32 v67, 1.0
    s_mov_b32 s70, 0xbdd2d3e8
    s_mov_b32 s71, 0xbdd2d3e8
    s_waitcnt lgkmcnt(0)
    v_lshlrev_b32 v68, 16, v60
    v_and_b32 v69, 0xffff0000, v60
    v_lshlrev_b32 v70, 16, v61
    v_and_b32 v71, 0xffff0000, v61
    v_pk_fma_f32 v[136:137], v[48:49], v[32:33], v[136:137] op_sel:[0,0,0] op_sel_hi:[1,0,1]
    v_pk_fma_f32 v[138:139], v[50:51], v[32:33], v[138:139] op_sel:[0,0,0] op_sel_hi:[1,0,1]
    v_pk_fma_f32 v[140:141], v[48:49], v[32:33], v[140:141] op_sel:[0,1,0] op_sel_hi:[1,1,1]
    v_pk_fma_f32 v[142:143], v[50:51], v[32:33], v[142:143] op_sel:[0,1,0] op_sel_hi:[1,1,1]
    v_pk_fma_f32 v[136:137], v[136:137], v[36:37], v[68:69] op_sel:[0,0,0] op_sel_hi:[1,0,1]
    v_pk_fma_f32 v[138:139], v[138:139], v[36:37], v[70:71] op_sel:[0,0,0] op_sel_hi:[1,0,1]
    v_pk_fma_f32 v[140:141], v[140:141], v[36:37], v[68:69] op_sel:[0,1,0] op_sel_hi:[1,1,1]
    v_pk_fma_f32 v[142:143], v[142:143], v[36:37], v[70:71] op_sel:[0,1,0] op_sel_hi:[1,1,1]
    v_pk_mul_f32 v[88:89], v[136:137], v[136:137]
    v_pk_mul_f32 v[90:91], v[138:139], v[138:139]
    v_pk_mul_f32 v[92:93], v[140:141], v[140:141]
    v_pk_mul_f32 v[94:95], v[142:143], v[142:143]
    v_pk_fma_f32 v[88:89], v[88:89], s[70:71], v[64:65]
    v_pk_fma_f32 v[90:91], v[90:91], s[70:71], v[64:65]
    v_pk_fma_f32 v[92:93], v[92:93], s[70:71], v[64:65]
    v_pk_fma_f32 v[94:95], v[94:95], s[70:71], v[64:65]
    v_pk_mul_f32 v[88:89], v[88:89], v[136:137]
    v_pk_mul_f32 v[90:91], v[90:91], v[138:139]
    v_pk_mul_f32 v[92:93], v[92:93], v[140:141]
    v_pk_mul_f32 v[94:95], v[94:95], v[142:143]
    v_exp_f32 v88, v88
    v_exp_f32 v89, v89
    v_exp_f32 v90, v90
    v_exp_f32 v91, v91
    v_exp_f32 v92, v92
    v_exp_f32 v93, v93
    v_exp_f32 v94, v94
    v_exp_f32 v95, v95
    v_pk_add_f32 v[88:89], v[88:89], v[66:67]
    v_pk_add_f32 v[90:91], v[90:91], v[66:67]
    v_pk_add_f32 v[92:93], v[92:93], v[66:67]
    v_pk_add_f32 v[94:95], v[94:95], v[66:67]
    v_rcp_f32 v88, v88
    v_rcp_f32 v89, v89
    v_rcp_f32 v90, v90
    v_rcp_f32 v91, v91
    v_rcp_f32 v92, v92
    v_rcp_f32 v93, v93
    v_rcp_f32 v94, v94
    v_rcp_f32 v95, v95
    v_pk_mul_f32 v[136:137], v[136:137], v[88:89]
    v_pk_mul_f32 v[138:139], v[138:139], v[90:91]
    v_pk_mul_f32 v[140:141], v[140:141], v[92:93]
    v_pk_mul_f32 v[142:143], v[142:143], v[94:95]
    v_cvt_pk_bf16_f32 v136, v136, v137
    v_cvt_pk_bf16_f32 v137, v138, v139
    v_cvt_pk_bf16_f32 v140, v140, v141
    v_cvt_pk_bf16_f32 v141, v142, v143
    v_pk_fma_f32 v[144:145], v[48:49], v[34:35], v[144:145] op_sel:[0,0,0] op_sel_hi:[1,0,1]
    v_pk_fma_f32 v[146:147], v[50:51], v[34:35], v[146:147] op_sel:[0,0,0] op_sel_hi:[1,0,1]
    v_pk_fma_f32 v[148:149], v[48:49], v[34:35], v[148:149] op_sel:[0,1,0] op_sel_hi:[1,1,1]
    v_pk_fma_f32 v[150:151], v[50:51], v[34:35], v[150:151] op_sel:[0,1,0] op_sel_hi:[1,1,1]
    v_pk_fma_f32 v[144:145], v[144:145], v[38:39], v[68:69] op_sel:[0,0,0] op_sel_hi:[1,0,1]
    v_pk_fma_f32 v[146:147], v[146:147], v[38:39], v[70:71] op_sel:[0,0,0] op_sel_hi:[1,0,1]
    v_pk_fma_f32 v[148:149], v[148:149], v[38:39], v[68:69] op_sel:[0,1,0] op_sel_hi:[1,1,1]
    v_pk_fma_f32 v[150:151], v[150:151], v[38:39], v[70:71] op_sel:[0,1,0] op_sel_hi:[1,1,1]
    v_pk_mul_f32 v[88:89], v[144:145], v[144:145]
    v_pk_mul_f32 v[90:91], v[146:147], v[146:147]
    v_pk_mul_f32 v[92:93], v[148:149], v[148:149]
    v_pk_mul_f32 v[94:95], v[150:151], v[150:151]
    v_pk_fma_f32 v[88:89], v[88:89], s[70:71], v[64:65]
    v_pk_fma_f32 v[90:91], v[90:91], s[70:71], v[64:65]
    v_pk_fma_f32 v[92:93], v[92:93], s[70:71], v[64:65]
    v_pk_fma_f32 v[94:95], v[94:95], s[70:71], v[64:65]
    v_pk_mul_f32 v[88:89], v[88:89], v[144:145]
    v_pk_mul_f32 v[90:91], v[90:91], v[146:147]
    v_pk_mul_f32 v[92:93], v[92:93], v[148:149]
    v_pk_mul_f32 v[94:95], v[94:95], v[150:151]
    v_exp_f32 v88, v88
    v_exp_f32 v89, v89
    v_exp_f32 v90, v90
    v_exp_f32 v91, v91
    v_exp_f32 v92, v92
    v_exp_f32 v93, v93
    v_exp_f32 v94, v94
    v_exp_f32 v95, v95
    v_pk_add_f32 v[88:89], v[88:89], v[66:67]
    v_pk_add_f32 v[90:91], v[90:91], v[66:67]
    v_pk_add_f32 v[92:93], v[92:93], v[66:67]
    v_pk_add_f32 v[94:95], v[94:95], v[66:67]
    v_rcp_f32 v88, v88
    v_rcp_f32 v89, v89
    v_rcp_f32 v90, v90
    v_rcp_f32 v91, v91
    v_rcp_f32 v92, v92
    v_rcp_f32 v93, v93
    v_rcp_f32 v94, v94
    v_rcp_f32 v95, v95
    v_pk_mul_f32 v[144:145], v[144:145], v[88:89]
    v_pk_mul_f32 v[146:147], v[146:147], v[90:91]
    v_pk_mul_f32 v[148:149], v[148:149], v[92:93]
    v_pk_mul_f32 v[150:151], v[150:151], v[94:95]
    v_cvt_pk_bf16_f32 v144, v144, v145
    v_cvt_pk_bf16_f32 v145, v146, v147
    v_cvt_pk_bf16_f32 v148, v148, v149
    v_cvt_pk_bf16_f32 v149, v150, v151
    v_lshlrev_b32 v68, 16, v62
    v_and_b32 v69, 0xffff0000, v62
    v_lshlrev_b32 v70, 16, v63
    v_and_b32 v71, 0xffff0000, v63
    v_pk_fma_f32 v[152:153], v[52:53], v[32:33], v[152:153] op_sel:[0,0,0] op_sel_hi:[1,0,1]
    v_pk_fma_f32 v[154:155], v[54:55], v[32:33], v[154:155] op_sel:[0,0,0] op_sel_hi:[1,0,1]
    v_pk_fma_f32 v[156:157], v[52:53], v[32:33], v[156:157] op_sel:[0,1,0] op_sel_hi:[1,1,1]
    v_pk_fma_f32 v[158:159], v[54:55], v[32:33], v[158:159] op_sel:[0,1,0] op_sel_hi:[1,1,1]
    v_pk_fma_f32 v[152:153], v[152:153], v[36:37], v[68:69] op_sel:[0,0,0] op_sel_hi:[1,0,1]
    v_pk_fma_f32 v[154:155], v[154:155], v[36:37], v[70:71] op_sel:[0,0,0] op_sel_hi:[1,0,1]
    v_pk_fma_f32 v[156:157], v[156:157], v[36:37], v[68:69] op_sel:[0,1,0] op_sel_hi:[1,1,1]
    v_pk_fma_f32 v[158:159], v[158:159], v[36:37], v[70:71] op_sel:[0,1,0] op_sel_hi:[1,1,1]
    v_pk_mul_f32 v[88:89], v[152:153], v[152:153]
    v_pk_mul_f32 v[90:91], v[154:155], v[154:155]
    v_pk_mul_f32 v[92:93], v[156:157], v[156:157]
    v_pk_mul_f32 v[94:95], v[158:159], v[158:159]
    v_pk_fma_f32 v[88:89], v[88:89], s[70:71], v[64:65]
    v_pk_fma_f32 v[90:91], v[90:91], s[70:71], v[64:65]
    v_pk_fma_f32 v[92:93], v[92:93], s[70:71], v[64:65]
    v_pk_fma_f32 v[94:95], v[94:95], s[70:71], v[64:65]
    v_pk_mul_f32 v[88:89], v[88:89], v[152:153]
    v_pk_mul_f32 v[90:91], v[90:91], v[154:155]
    v_pk_mul_f32 v[92:93], v[92:93], v[156:157]
    v_pk_mul_f32 v[94:95], v[94:95], v[158:159]
    v_exp_f32 v88, v88
    v_exp_f32 v89, v89
    v_exp_f32 v90, v90
    v_exp_f32 v91, v91
    v_exp_f32 v92, v92
    v_exp_f32 v93, v93
    v_exp_f32 v94, v94
    v_exp_f32 v95, v95
    v_pk_add_f32 v[88:89], v[88:89], v[66:67]
    v_pk_add_f32 v[90:91], v[90:91], v[66:67]
    v_pk_add_f32 v[92:93], v[92:93], v[66:67]
    v_pk_add_f32 v[94:95], v[94:95], v[66:67]
    v_rcp_f32 v88, v88
    v_rcp_f32 v89, v89
    v_rcp_f32 v90, v90
    v_rcp_f32 v91, v91
    v_rcp_f32 v92, v92
    v_rcp_f32 v93, v93
    v_rcp_f32 v94, v94
    v_rcp_f32 v95, v95
    v_pk_mul_f32 v[152:153], v[152:153], v[88:89]
    v_pk_mul_f32 v[154:155], v[154:155], v[90:91]
    v_pk_mul_f32 v[156:157], v[156:157], v[92:93]
    v_pk_mul_f32 v[158:159], v[158:159], v[94:95]
    v_cvt_pk_bf16_f32 v138, v152, v153
    v_cvt_pk_bf16_f32 v139, v154, v155
    v_cvt_pk_bf16_f32 v142, v156, v157
    v_cvt_pk_bf16_f32 v143, v158, v159
    v_pk_fma_f32 v[160:161], v[52:53], v[34:35], v[160:161] op_sel:[0,0,0] op_sel_hi:[1,0,1]
    v_pk_fma_f32 v[162:163], v[54:55], v[34:35], v[162:163] op_sel:[0,0,0] op_sel_hi:[1,0,1]
    v_pk_fma_f32 v[164:165], v[52:53], v[34:35], v[164:165] op_sel:[0,1,0] op_sel_hi:[1,1,1]
    v_pk_fma_f32 v[166:167], v[54:55], v[34:35], v[166:167] op_sel:[0,1,0] op_sel_hi:[1,1,1]
    v_pk_fma_f32 v[160:161], v[160:161], v[38:39], v[68:69] op_sel:[0,0,0] op_sel_hi:[1,0,1]
    v_pk_fma_f32 v[162:163], v[162:163], v[38:39], v[70:71] op_sel:[0,0,0] op_sel_hi:[1,0,1]
    v_pk_fma_f32 v[164:165], v[164:165], v[38:39], v[68:69] op_sel:[0,1,0] op_sel_hi:[1,1,1]
    v_pk_fma_f32 v[166:167], v[166:167], v[38:39], v[70:71] op_sel:[0,1,0] op_sel_hi:[1,1,1]
    v_pk_mul_f32 v[88:89], v[160:161], v[160:161]
    v_pk_mul_f32 v[90:91], v[162:163], v[162:163]
    v_pk_mul_f32 v[92:93], v[164:165], v[164:165]
    v_pk_mul_f32 v[94:95], v[166:167], v[166:167]
    v_pk_fma_f32 v[88:89], v[88:89], s[70:71], v[64:65]
    v_pk_fma_f32 v[90:91], v[90:91], s[70:71], v[64:65]
    v_pk_fma_f32 v[92:93], v[92:93], s[70:71], v[64:65]
    v_pk_fma_f32 v[94:95], v[94:95], s[70:71], v[64:65]
    v_pk_mul_f32 v[88:89], v[88:89], v[160:161]
    v_pk_mul_f32 v[90:91], v[90:91], v[162:163]
    v_pk_mul_f32 v[92:93], v[92:93], v[164:165]
    v_pk_mul_f32 v[94:95], v[94:95], v[166:167]
    v_exp_f32 v88, v88
    v_exp_f32 v89, v89
    v_exp_f32 v90, v90
    v_exp_f32 v91, v91
    v_exp_f32 v92, v92
    v_exp_f32 v93, v93
    v_exp_f32 v94, v94
    v_exp_f32 v95, v95
    v_pk_add_f32 v[88:89], v[88:89], v[66:67]
    v_pk_add_f32 v[90:91], v[90:91], v[66:67]
    v_pk_add_f32 v[92:93], v[92:93], v[66:67]
    v_pk_add_f32 v[94:95], v[94:95], v[66:67]
    v_rcp_f32 v88, v88
    v_rcp_f32 v89, v89
    v_rcp_f32 v90, v90
    v_rcp_f32 v91, v91
    v_rcp_f32 v92, v92
    v_rcp_f32 v93, v93
    v_rcp_f32 v94, v94
    v_rcp_f32 v95, v95
    v_pk_mul_f32 v[160:161], v[160:161], v[88:89]
    v_pk_mul_f32 v[162:163], v[162:163], v[90:91]
    v_pk_mul_f32 v[164:165], v[164:165], v[92:93]
    v_pk_mul_f32 v[166:167], v[166:167], v[94:95]
    v_cvt_pk_bf16_f32 v146, v160, v161
    v_cvt_pk_bf16_f32 v147, v162, v163
    v_cvt_pk_bf16_f32 v150, v164, v165
    v_cvt_pk_bf16_f32 v151, v166, v167
    v_lshlrev_b32 v68, 16, v56
    v_and_b32 v69, 0xffff0000, v56
    v_lshlrev_b32 v70, 16, v57
    v_and_b32 v71, 0xffff0000, v57
    v_pk_fma_f32 v[104:105], v[40:41], v[32:33], v[104:105] op_sel:[0,0,0] op_sel_hi:[1,0,1]
    v_pk_fma_f32 v[106:107], v[42:43], v[32:33], v[106:107] op_sel:[0,0,0] op_sel_hi:[1,0,1]
    v_pk_fma_f32 v[108:109], v[40:41], v[32:33], v[108:109] op_sel:[0,1,0] op_sel_hi:[1,1,1]
    v_pk_fma_f32 v[110:111], v[42:43], v[32:33], v[110:111] op_sel:[0,1,0] op_sel_hi:[1,1,1]
    v_pk_fma_f32 v[104:105], v[104:105], v[36:37], v[68:69] op_sel:[0,0,0] op_sel_hi:[1,0,1]
    v_pk_fma_f32 v[106:107], v[106:107], v[36:37], v[70:71] op_sel:[0,0,0] op_sel_hi:[1,0,1]
    v_pk_fma_f32 v[108:109], v[108:109], v[36:37], v[68:69] op_sel:[0,1,0] op_sel_hi:[1,1,1]
    v_pk_fma_f32 v[110:111], v[110:111], v[36:37], v[70:71] op_sel:[0,1,0] op_sel_hi:[1,1,1]
    v_pk_mul_f32 v[88:89], v[104:105], v[104:105]
    v_pk_mul_f32 v[90:91], v[106:107], v[106:107]
    v_pk_mul_f32 v[92:93], v[108:109], v[108:109]
    v_pk_mul_f32 v[94:95], v[110:111], v[110:111]
    v_pk_fma_f32 v[88:89], v[88:89], s[70:71], v[64:65]
    v_pk_fma_f32 v[90:91], v[90:91], s[70:71], v[64:65]
    v_pk_fma_f32 v[92:93], v[92:93], s[70:71], v[64:65]
    v_pk_fma_f32 v[94:95], v[94:95], s[70:71], v[64:65]
    v_pk_mul_f32 v[88:89], v[88:89], v[104:105]
    v_pk_mul_f32 v[90:91], v[90:91], v[106:107]
    v_pk_mul_f32 v[92:93], v[92:93], v[108:109]
    v_pk_mul_f32 v[94:95], v[94:95], v[110:111]
    v_exp_f32 v88, v88
    v_exp_f32 v89, v89
    v_exp_f32 v90, v90
    v_exp_f32 v91, v91
    v_exp_f32 v92, v92
    v_exp_f32 v93, v93
    v_exp_f32 v94, v94
    v_exp_f32 v95, v95
    v_pk_add_f32 v[88:89], v[88:89], v[66:67]
    v_pk_add_f32 v[90:91], v[90:91], v[66:67]
    v_pk_add_f32 v[92:93], v[92:93], v[66:67]
    v_pk_add_f32 v[94:95], v[94:95], v[66:67]
    v_rcp_f32 v88, v88
    v_rcp_f32 v89, v89
    v_rcp_f32 v90, v90
    v_rcp_f32 v91, v91
    v_rcp_f32 v92, v92
    v_rcp_f32 v93, v93
    v_rcp_f32 v94, v94
    v_rcp_f32 v95, v95
    v_pk_mul_f32 v[104:105], v[104:105], v[88:89]
    v_pk_mul_f32 v[106:107], v[106:107], v[90:91]
    v_pk_mul_f32 v[108:109], v[108:109], v[92:93]
    v_pk_mul_f32 v[110:111], v[110:111], v[94:95]
    v_cvt_pk_bf16_f32 v152, v104, v105
    v_cvt_pk_bf16_f32 v153, v106, v107
    v_cvt_pk_bf16_f32 v156, v108, v109
    v_cvt_pk_bf16_f32 v157, v110, v111
    v_pk_fma_f32 v[112:113], v[40:41], v[34:35], v[112:113] op_sel:[0,0,0] op_sel_hi:[1,0,1]
    v_pk_fma_f32 v[114:115], v[42:43], v[34:35], v[114:115] op_sel:[0,0,0] op_sel_hi:[1,0,1]
    v_pk_fma_f32 v[116:117], v[40:41], v[34:35], v[116:117] op_sel:[0,1,0] op_sel_hi:[1,1,1]
    v_pk_fma_f32 v[118:119], v[42:43], v[34:35], v[118:119] op_sel:[0,1,0] op_sel_hi:[1,1,1]
    v_pk_fma_f32 v[112:113], v[112:113], v[38:39], v[68:69] op_sel:[0,0,0] op_sel_hi:[1,0,1]
    v_pk_fma_f32 v[114:115], v[114:115], v[38:39], v[70:71] op_sel:[0,0,0] op_sel_hi:[1,0,1]
    v_pk_fma_f32 v[116:117], v[116:117], v[38:39], v[68:69] op_sel:[0,1,0] op_sel_hi:[1,1,1]
    v_pk_fma_f32 v[118:119], v[118:119], v[38:39], v[70:71] op_sel:[0,1,0] op_sel_hi:[1,1,1]
    v_pk_mul_f32 v[88:89], v[112:113], v[112:113]
    v_pk_mul_f32 v[90:91], v[114:115], v[114:115]
    v_pk_mul_f32 v[92:93], v[116:117], v[116:117]
    v_pk_mul_f32 v[94:95], v[118:119], v[118:119]
    v_pk_fma_f32 v[88:89], v[88:89], s[70:71], v[64:65]
    v_pk_fma_f32 v[90:91], v[90:91], s[70:71], v[64:65]
    v_pk_fma_f32 v[92:93], v[92:93], s[70:71], v[64:65]
    v_pk_fma_f32 v[94:95], v[94:95], s[70:71], v[64:65]
    v_pk_mul_f32 v[88:89], v[88:89], v[112:113]
    v_pk_mul_f32 v[90:91], v[90:91], v[114:115]
    v_pk_mul_f32 v[92:93], v[92:93], v[116:117]
    v_pk_mul_f32 v[94:95], v[94:95], v[118:119]
    v_exp_f32 v88, v88
    v_exp_f32 v89, v89
    v_exp_f32 v90, v90
    v_exp_f32 v91, v91
    v_exp_f32 v92, v92
    v_exp_f32 v93, v93
    v_exp_f32 v94, v94
    v_exp_f32 v95, v95
    v_pk_add_f32 v[88:89], v[88:89], v[66:67]
    v_pk_add_f32 v[90:91], v[90:91], v[66:67]
    v_pk_add_f32 v[92:93], v[92:93], v[66:67]
    v_pk_add_f32 v[94:95], v[94:95], v[66:67]
    v_rcp_f32 v88, v88
    v_rcp_f32 v89, v89
    v_rcp_f32 v90, v90
    v_rcp_f32 v91, v91
    v_rcp_f32 v92, v92
    v_rcp_f32 v93, v93
    v_rcp_f32 v94, v94
    v_rcp_f32 v95, v95
    v_pk_mul_f32 v[112:113], v[112:113], v[88:89]
    v_pk_mul_f32 v[114:115], v[114:115], v[90:91]
    v_pk_mul_f32 v[116:117], v[116:117], v[92:93]
    v_pk_mul_f32 v[118:119], v[118:119], v[94:95]
    v_cvt_pk_bf16_f32 v160, v112, v113
    v_cvt_pk_bf16_f32 v161, v114, v115
    v_cvt_pk_bf16_f32 v164, v116, v117
    v_cvt_pk_bf16_f32 v165, v118, v119
    v_lshlrev_b32 v68, 16, v58
    v_and_b32 v69, 0xffff0000, v58
    v_lshlrev_b32 v70, 16, v59
    v_and_b32 v71, 0xffff0000, v59
    v_pk_fma_f32 v[120:121], v[44:45], v[32:33], v[120:121] op_sel:[0,0,0] op_sel_hi:[1,0,1]
    v_pk_fma_f32 v[122:123], v[46:47], v[32:33], v[122:123] op_sel:[0,0,0] op_sel_hi:[1,0,1]
    v_pk_fma_f32 v[124:125], v[44:45], v[32:33], v[124:125] op_sel:[0,1,0] op_sel_hi:[1,1,1]
    v_pk_fma_f32 v[126:127], v[46:47], v[32:33], v[126:127] op_sel:[0,1,0] op_sel_hi:[1,1,1]
    v_pk_fma_f32 v[120:121], v[120:121], v[36:37], v[68:69] op_sel:[0,0,0] op_sel_hi:[1,0,1]
    v_pk_fma_f32 v[122:123], v[122:123], v[36:37], v[70:71] op_sel:[0,0,0] op_sel_hi:[1,0,1]
    v_pk_fma_f32 v[124:125], v[124:125], v[36:37], v[68:69] op_sel:[0,1,0] op_sel_hi:[1,1,1]
    v_pk_fma_f32 v[126:127], v[126:127], v[36:37], v[70:71] op_sel:[0,1,0] op_sel_hi:[1,1,1]
    v_pk_mul_f32 v[88:89], v[120:121], v[120:121]
    v_pk_mul_f32 v[90:91], v[122:123], v[122:123]
    v_pk_mul_f32 v[92:93], v[124:125], v[124:125]
    v_pk_mul_f32 v[94:95], v[126:127], v[126:127]
    v_pk_fma_f32 v[88:89], v[88:89], s[70:71], v[64:65]
    v_pk_fma_f32 v[90:91], v[90:91], s[70:71], v[64:65]
    v_pk_fma_f32 v[92:93], v[92:93], s[70:71], v[64:65]
    v_pk_fma_f32 v[94:95], v[94:95], s[70:71], v[64:65]
    v_pk_mul_f32 v[88:89], v[88:89], v[120:121]
    v_pk_mul_f32 v[90:91], v[90:91], v[122:123]
    v_pk_mul_f32 v[92:93], v[92:93], v[124:125]
    v_pk_mul_f32 v[94:95], v[94:95], v[126:127]
    v_exp_f32 v88, v88
    v_exp_f32 v89, v89
    v_exp_f32 v90, v90
    v_exp_f32 v91, v91
    v_exp_f32 v92, v92
    v_exp_f32 v93, v93
    v_exp_f32 v94, v94
    v_exp_f32 v95, v95
    v_pk_add_f32 v[88:89], v[88:89], v[66:67]
    v_pk_add_f32 v[90:91], v[90:91], v[66:67]
    v_pk_add_f32 v[92:93], v[92:93], v[66:67]
    v_pk_add_f32 v[94:95], v[94:95], v[66:67]
    v_rcp_f32 v88, v88
    v_rcp_f32 v89, v89
    v_rcp_f32 v90, v90
    v_rcp_f32 v91, v91
    v_rcp_f32 v92, v92
    v_rcp_f32 v93, v93
    v_rcp_f32 v94, v94
    v_rcp_f32 v95, v95
    v_pk_mul_f32 v[120:121], v[120:121], v[88:89]
    v_pk_mul_f32 v[122:123], v[122:123], v[90:91]
    v_pk_mul_f32 v[124:125], v[124:125], v[92:93]
    v_pk_mul_f32 v[126:127], v[126:127], v[94:95]
    v_cvt_pk_bf16_f32 v154, v120, v121
    v_cvt_pk_bf16_f32 v155, v122, v123
    v_cvt_pk_bf16_f32 v158, v124, v125
    v_cvt_pk_bf16_f32 v159, v126, v127
    v_pk_fma_f32 v[128:129], v[44:45], v[34:35], v[128:129] op_sel:[0,0,0] op_sel_hi:[1,0,1]
    v_pk_fma_f32 v[130:131], v[46:47], v[34:35], v[130:131] op_sel:[0,0,0] op_sel_hi:[1,0,1]
    v_pk_fma_f32 v[132:133], v[44:45], v[34:35], v[132:133] op_sel:[0,1,0] op_sel_hi:[1,1,1]
    v_pk_fma_f32 v[134:135], v[46:47], v[34:35], v[134:135] op_sel:[0,1,0] op_sel_hi:[1,1,1]
    v_pk_fma_f32 v[128:129], v[128:129], v[38:39], v[68:69] op_sel:[0,0,0] op_sel_hi:[1,0,1]
    v_pk_fma_f32 v[130:131], v[130:131], v[38:39], v[70:71] op_sel:[0,0,0] op_sel_hi:[1,0,1]
    v_pk_fma_f32 v[132:133], v[132:133], v[38:39], v[68:69] op_sel:[0,1,0] op_sel_hi:[1,1,1]
    v_pk_fma_f32 v[134:135], v[134:135], v[38:39], v[70:71] op_sel:[0,1,0] op_sel_hi:[1,1,1]
    v_pk_mul_f32 v[88:89], v[128:129], v[128:129]
    v_pk_mul_f32 v[90:91], v[130:131], v[130:131]
    v_pk_mul_f32 v[92:93], v[132:133], v[132:133]
    v_pk_mul_f32 v[94:95], v[134:135], v[134:135]
    v_pk_fma_f32 v[88:89], v[88:89], s[70:71], v[64:65]
    v_pk_fma_f32 v[90:91], v[90:91], s[70:71], v[64:65]
    v_pk_fma_f32 v[92:93], v[92:93], s[70:71], v[64:65]
    v_pk_fma_f32 v[94:95], v[94:95], s[70:71], v[64:65]
    v_pk_mul_f32 v[88:89], v[88:89], v[128:129]
    v_pk_mul_f32 v[90:91], v[90:91], v[130:131]
    v_pk_mul_f32 v[92:93], v[92:93], v[132:133]
    v_pk_mul_f32 v[94:95], v[94:95], v[134:135]
    v_exp_f32 v88, v88
    v_exp_f32 v89, v89
    v_exp_f32 v90, v90
    v_exp_f32 v91, v91
    v_exp_f32 v92, v92
    v_exp_f32 v93, v93
    v_exp_f32 v94, v94
    v_exp_f32 v95, v95
    v_pk_add_f32 v[88:89], v[88:89], v[66:67]
    v_pk_add_f32 v[90:91], v[90:91], v[66:67]
    v_pk_add_f32 v[92:93], v[92:93], v[66:67]
    v_pk_add_f32 v[94:95], v[94:95], v[66:67]
    v_rcp_f32 v88, v88
    v_rcp_f32 v89, v89
    v_rcp_f32 v90, v90
    v_rcp_f32 v91, v91
    v_rcp_f32 v92, v92
    v_rcp_f32 v93, v93
    v_rcp_f32 v94, v94
    v_rcp_f32 v95, v95
    v_pk_mul_f32 v[128:129], v[128:129], v[88:89]
    v_pk_mul_f32 v[130:131], v[130:131], v[90:91]
    v_pk_mul_f32 v[132:133], v[132:133], v[92:93]
    v_pk_mul_f32 v[134:135], v[134:135], v[94:95]
    v_cvt_pk_bf16_f32 v162, v128, v129
    v_cvt_pk_bf16_f32 v163, v130, v131
    v_cvt_pk_bf16_f32 v166, v132, v133
    v_cvt_pk_bf16_f32 v167, v134, v135
    s_sub_u32 s62, s44, 8
    s_mul_i32 s62, s62, 8704
    s_add_u32 s62, s62, 114688
    v_lshlrev_b32 v72, 4, v1
    v_add_u32 v72, s62, v72
    ds_write_b128 v72, v[136:139] offset:0
    ds_write_b128 v72, v[140:143] offset:1024
    ds_write_b128 v72, v[144:147] offset:2048
    ds_write_b128 v72, v[148:151] offset:3072
    ds_write_b128 v72, v[152:155] offset:4096
    ds_write_b128 v72, v[156:159] offset:5120
    ds_write_b128 v72, v[160:163] offset:6144
    ds_write_b128 v72, v[164:167] offset:7168
    v_lshlrev_b32 v72, 3, v1
    v_add_u32 v72, s62, v72
    ds_write_b64 v72, v[12:13] offset:8192
    s_branch P2_ENTRY
K1_EPI_V:
    v_add_u32 v73, s64, v74
    ds_read_b128 v[40:43], v73 offset:0
    ds_read_b128 v[44:47], v73 offset:64
    ds_read_b128 v[48:51], v73 offset:128
    ds_read_b128 v[52:55], v73 offset:192
    ds_read_b128 v[56:59], v73 offset:512
    ds_read_b128 v[60:63], v73 offset:576
    ds_read_b128 v[64:67], v73 offset:640
    ds_read_b128 v[68:71], v73 offset:704
    v_add_u32 v75, s65, v72
    ds_read_b32 v88, v75 offset:0
    ds_read_b32 v90, v75 offset:64
    ds_read_b32 v92, v75 offset:128
    ds_read_b32 v94, v75 offset:192
    s_waitcnt lgkmcnt(0)
    v_pk_fma_f32 v[104:105], v[40:41], v[88:89], v[104:105] op_sel:[0,0,0] op_sel_hi:[1,0,1]
    v_pk_fma_f32 v[106:107], v[42:43], v[88:89], v[106:107] op_sel:[0,0,0] op_sel_hi:[1,0,1]
    v_pk_fma_f32 v[108:109], v[44:45], v[88:89], v[108:109] op_sel:[0,0,0] op_sel_hi:[1,0,1]
    v_pk_fma_f32 v[110:111], v[46:47], v[88:89], v[110:111] op_sel:[0,0,0] op_sel_hi:[1,0,1]
    v_pk_fma_f32 v[112:113], v[48:49], v[88:89], v[112:113] op_sel:[0,0,0] op_sel_hi:[1,0,1]
    v_pk_fma_f32 v[114:115], v[50:51], v[88:89], v[114:115] op_sel:[0,0,0] op_sel_hi:[1,0,1]
    v_pk_fma_f32 v[116:117], v[52:53], v[88:89], v[116:117] op_sel:[0,0,0] op_sel_hi:[1,0,1]
    v_pk_fma_f32 v[118:119], v[54:55], v[88:89], v[118:119] op_sel:[0,0,0] op_sel_hi:[1,0,1]
    v_pk_mul_f32 v[104:105], v[104:105], v[56:57]
    v_pk_mul_f32 v[106:107], v[106:107], v[58:59]
    v_pk_mul_f32 v[108:109], v[108:109], v[60:61]
    v_pk_mul_f32 v[110:111], v[110:111], v[62:63]
    v_pk_mul_f32 v[112:113], v[112:113], v[64:65]
    v_pk_mul_f32 v[114:115], v[114:115], v[66:67]
    v_pk_mul_f32 v[116:117], v[116:117], v[68:69]
    v_pk_mul_f32 v[118:119], v[118:119], v[70:71]
    v_cvt_pk_bf16_f32 v104, v104, v105
    v_cvt_pk_bf16_f32 v105, v106, v107
    v_cvt_pk_bf16_f32 v106, v108, v109
    v_cvt_pk_bf16_f32 v107, v110, v111
    ds_write_b128 v8, v[104:107] offset:0
    v_cvt_pk_bf16_f32 v112, v112, v113
    v_cvt_pk_bf16_f32 v113, v114, v115
    v_cvt_pk_bf16_f32 v114, v116, v117
    v_cvt_pk_bf16_f32 v115, v118, v119
    v_xor_b32 v8, 64, v8
    ds_write_b128 v8, v[112:115] offset:0
    v_pk_fma_f32 v[120:121], v[40:41], v[90:91], v[120:121] op_sel:[0,0,0] op_sel_hi:[1,0,1]
    v_pk_fma_f32 v[122:123], v[42:43], v[90:91], v[122:123] op_sel:[0,0,0] op_sel_hi:[1,0,1]
    v_pk_fma_f32 v[124:125], v[44:45], v[90:91], v[124:125] op_sel:[0,0,0] op_sel_hi:[1,0,1]
    v_pk_fma_f32 v[126:127], v[46:47], v[90:91], v[126:127] op_sel:[0,0,0] op_sel_hi:[1,0,1]
    v_pk_fma_f32 v[128:129], v[48:49], v[90:91], v[128:129] op_sel:[0,0,0] op_sel_hi:[1,0,1]
    v_pk_fma_f32 v[130:131], v[50:51], v[90:91], v[130:131] op_sel:[0,0,0] op_sel_hi:[1,0,1]
    v_pk_fma_f32 v[132:133], v[52:53], v[90:91], v[132:133] op_sel:[0,0,0] op_sel_hi:[1,0,1]
    v_pk_fma_f32 v[134:135], v[54:55], v[90:91], v[134:135] op_sel:[0,0,0] op_sel_hi:[1,0,1]
    v_pk_mul_f32 v[120:121], v[120:121], v[56:57]
    v_pk_mul_f32 v[122:123], v[122:123], v[58:59]
    v_pk_mul_f32 v[124:125], v[124:125], v[60:61]
    v_pk_mul_f32 v[126:127], v[126:127], v[62:63]
    v_pk_mul_f32 v[128:129], v[128:129], v[64:65]
    v_pk_mul_f32 v[130:131], v[130:131], v[66:67]
    v_pk_mul_f32 v[132:133], v[132:133], v[68:69]
    v_pk_mul_f32 v[134:135], v[134:135], v[70:71]
    v_cvt_pk_bf16_f32 v120, v120, v121
    v_cvt_pk_bf16_f32 v121, v122, v123
    v_cvt_pk_bf16_f32 v122, v124, v125
    v_cvt_pk_bf16_f32 v123, v126, v127
    ds_write_b128 v9, v[120:123] offset:2048
    v_cvt_pk_bf16_f32 v128, v128, v129
    v_cvt_pk_bf16_f32 v129, v130, v131
    v_cvt_pk_bf16_f32 v130, v132, v133
    v_cvt_pk_bf16_f32 v131, v134, v135
    v_xor_b32 v9, 64, v9
    ds_write_b128 v9, v[128:131] offset:2048
    v_pk_fma_f32 v[136:137], v[40:41], v[92:93], v[136:137] op_sel:[0,0,0] op_sel_hi:[1,0,1]
    v_pk_fma_f32 v[138:139], v[42:43], v[92:93], v[138:139] op_sel:[0,0,0] op_sel_hi:[1,0,1]
    v_pk_fma_f32 v[140:141], v[44:45], v[92:93], v[140:141] op_sel:[0,0,0] op_sel_hi:[1,0,1]
    v_pk_fma_f32 v[142:143], v[46:47], v[92:93], v[142:143] op_sel:[0,0,0] op_sel_hi:[1,0,1]
    v_pk_fma_f32 v[144:145], v[48:49], v[92:93], v[144:145] op_sel:[0,0,0] op_sel_hi:[1,0,1]
    v_pk_fma_f32 v[146:147], v[50:51], v[92:93], v[146:147] op_sel:[0,0,0] op_sel_hi:[1,0,1]
    v_pk_fma_f32 v[148:149], v[52:53], v[92:93], v[148:149] op_sel:[0,0,0] op_sel_hi:[1,0,1]
    v_pk_fma_f32 v[150:151], v[54:55], v[92:93], v[150:151] op_sel:[0,0,0] op_sel_hi:[1,0,1]
    v_pk_mul_f32 v[136:137], v[136:137], v[56:57]
    v_pk_mul_f32 v[138:139], v[138:139], v[58:59]
    v_pk_mul_f32 v[140:141], v[140:141], v[60:61]
    v_pk_mul_f32 v[142:143], v[142:143], v[62:63]
    v_pk_mul_f32 v[144:145], v[144:145], v[64:65]
    v_pk_mul_f32 v[146:147], v[146:147], v[66:67]
    v_pk_mul_f32 v[148:149], v[148:149], v[68:69]
    v_pk_mul_f32 v[150:151], v[150:151], v[70:71]
    v_cvt_pk_bf16_f32 v136, v136, v137
    v_cvt_pk_bf16_f32 v137, v138, v139
    v_cvt_pk_bf16_f32 v138, v140, v141
    v_cvt_pk_bf16_f32 v139, v142, v143
    ds_write_b128 v10, v[136:139] offset:4096
    v_cvt_pk_bf16_f32 v144, v144, v145
    v_cvt_pk_bf16_f32 v145, v146, v147
    v_cvt_pk_bf16_f32 v146, v148, v149
    v_cvt_pk_bf16_f32 v147, v150, v151
    v_xor_b32 v10, 64, v10
    ds_write_b128 v10, v[144:147] offset:4096
    v_pk_fma_f32 v[152:153], v[40:41], v[94:95], v[152:153] op_sel:[0,0,0] op_sel_hi:[1,0,1]
    v_pk_fma_f32 v[154:155], v[42:43], v[94:95], v[154:155] op_sel:[0,0,0] op_sel_hi:[1,0,1]
    v_pk_fma_f32 v[156:157], v[44:45], v[94:95], v[156:157] op_sel:[0,0,0] op_sel_hi:[1,0,1]
    v_pk_fma_f32 v[158:159], v[46:47], v[94:95], v[158:159] op_sel:[0,0,0] op_sel_hi:[1,0,1]
    v_pk_fma_f32 v[160:161], v[48:49], v[94:95], v[160:161] op_sel:[0,0,0] op_sel_hi:[1,0,1]
    v_pk_fma_f32 v[162:163], v[50:51], v[94:95], v[162:163] op_sel:[0,0,0] op_sel_hi:[1,0,1]
    v_pk_fma_f32 v[164:165], v[52:53], v[94:95], v[164:165] op_sel:[0,0,0] op_sel_hi:[1,0,1]
    v_pk_fma_f32 v[166:167], v[54:55], v[94:95], v[166:167] op_sel:[0,0,0] op_sel_hi:[1,0,1]
    v_pk_mul_f32 v[152:153], v[152:153], v[56:57]
    v_pk_mul_f32 v[154:155], v[154:155], v[58:59]
    v_pk_mul_f32 v[156:157], v[156:157], v[60:61]
    v_pk_mul_f32 v[158:159], v[158:159], v[62:63]
    v_pk_mul_f32 v[160:161], v[160:161], v[64:65]
    v_pk_mul_f32 v[162:163], v[162:163], v[66:67]
    v_pk_mul_f32 v[164:165], v[164:165], v[68:69]
    v_pk_mul_f32 v[166:167], v[166:167], v[70:71]
    v_cvt_pk_bf16_f32 v152, v152, v153
    v_cvt_pk_bf16_f32 v153, v154, v155
    v_cvt_pk_bf16_f32 v154, v156, v157
    v_cvt_pk_bf16_f32 v155, v158, v159
    ds_write_b128 v11, v[152:155] offset:6144
    v_cvt_pk_bf16_f32 v160, v160, v161
    v_cvt_pk_bf16_f32 v161, v162, v163
    v_cvt_pk_bf16_f32 v162, v164, v165
    v_cvt_pk_bf16_f32 v163, v166, v167
    v_xor_b32 v11, 64, v11
    ds_write_b128 v11, v[160:163] offset:6144
    s_lshl_b32 s65, s44, 13
    v_lshlrev_b32 v72, 4, v1
    v_add_u32 v72, s65, v72
    s_waitcnt lgkmcnt(0)
    ds_read_b128 v[40:43], v72 offset:0
    ds_read_b128 v[44:47], v72 offset:1024
    ds_read_b128 v[48:51], v72 offset:2048
    ds_read_b128 v[52:55], v72 offset:3072
    ds_read_b128 v[56:59], v72 offset:4096
    ds_read_b128 v[60:63], v72 offset:5120
    ds_read_b128 v[64:67], v72 offset:6144
    ds_read_b128 v[68:71], v72 offset:7168
    s_waitcnt lgkmcnt(7)
    buffer_store_dwordx4 v[40:43], v12, s[32:35], 0 offen sc1
    s_waitcnt lgkmcnt(6)
    buffer_store_dwordx4 v[44:47], v13, s[32:35], 0 offen sc1
    s_waitcnt lgkmcnt(5)
    buffer_store_dwordx4 v[48:51], v14, s[32:35], 0 offen sc1
    s_waitcnt lgkmcnt(4)
    buffer_store_dwordx4 v[52:55], v15, s[32:35], 0 offen sc1
    s_waitcnt lgkmcnt(3)
    buffer_store_dwordx4 v[56:59], v16, s[32:35], 0 offen sc1
    s_waitcnt lgkmcnt(2)
    buffer_store_dwordx4 v[60:63], v17, s[32:35], 0 offen sc1
    s_waitcnt lgkmcnt(1)
    buffer_store_dwordx4 v[64:67], v18, s[32:35], 0 offen sc1
    s_waitcnt lgkmcnt(0)
    buffer_store_dwordx4 v[68:71], v19, s[32:35], 0 offen sc1
    s_branch K1_SIGQ
K1_SIGQ:
    v_mov_b32 v2, 153600
    v_mov_b32 v3, 1
    v_lshlrev_b32 v5, 11, v1
    s_lshl_b32 s62, s48, 7
    s_lshl_b32 s63, s47, 2
    s_add_u32 s62, s62, s63
    s_add_u32 s62, s62, 0x013c4400
    s_waitcnt vmcnt(0)
    s_mov_b64 exec, 1
    ds_add_rtn_u32 v4, v2, v3
    s_waitcnt lgkmcnt(0)
    v_readfirstlane_b32 s63, v4
    s_mov_b64 exec, -1
    s_cmp_lg_u32 s63, 3
    s_cbranch_scc1 P2_ENTRY
    s_mov_b64 exec, 15
    buffer_store_dword v3, v5, s[32:35], s62 offen sc1
    s_mov_b64 exec, -1
    s_branch P2_ENTRY
K1_TRANS:
    s_mul_i32 s51, s47, 12
    s_add_u32 s51, s51, s44
    s_mov_b32 s52, 0x05040100
    s_mov_b32 s53, 0x07060302
    v_lshlrev_b32 v72, 2, v1
    v_lshlrev_b32 v73, 4, v1
    s_lshl_b32 s62, s44, 13
    v_lshlrev_b32 v10, 5, v1
    v_add_u32 v10, s62, v10
    v_add_u32 v11, s62, v73
    s_waitcnt lgkmcnt(0)
    s_mov_b32 s32, s18
    s_mov_b32 s33, s19
    s_mov_b32 s34, 0x013cb000
    s_mov_b32 s35, 0x00020000
    s_lshl_b32 s62, s51, 3
    v_lshrrev_b32 v74, 3, v1
    v_add_u32 v74, s62, v74
    v_mul_u32_u24 v74, 5248, v74
    v_and_b32 v75, 7, v1
    v_lshl_add_u32 v74, v75, 4, v74
    s_cmp_lt_u32 s51, 128
    s_mov_b32 s62, 0x40000000
    s_cselect_b32 s62, 0x00280f00, s62
    v_mov_b32 v12, 0x3f803f80
    v_mov_b32 v13, 0x3f803f80
    v_mov_b32 v14, 0x3f803f80
    v_mov_b32 v15, 0x3f803f80
    buffer_store_dwordx4 v[12:15], v74, s[32:35], s62 offen sc1
    s_lshl_b32 s63, s44, 10
    s_add_u32 s63, s63, 0x013c4000
    s_cmp_eq_u32 s47, 0
    s_cselect_b32 s62, s63, 0x40000000
    v_mov_b32 v16, 0
    v_mov_b32 v17, 0
    v_mov_b32 v18, 0
    v_mov_b32 v19, 0
    v_lshlrev_b32 v75, 4, v1
    buffer_store_dwordx4 v[16:19], v75, s[32:35], s62 offen sc1
    v_mov_b32 v20, 153600
    ds_write_b128 v20, v[16:19]
    s_waitcnt vmcnt(0) lgkmcnt(0)
    s_barrier
    s_cmp_lg_u32 s44, 0
    s_cbranch_scc1 K1_TGO
    v_mov_b32 v21, 1
    s_cmp_lg_u32 s47, 0
    s_cbranch_scc1 K1_TZ
    s_mov_b32 s20, s10
    s_mov_b32 s21, s11
    s_mov_b32 s22, 0x00000100
    s_mov_b32 s23, 0x00020000
    s_mov_b64 exec, 1
    buffer_store_dword v21, v16, s[20:23], 0 offen sc1
    s_mov_b64 exec, -1
K1_TZ:
K1_TGO:
    s_mov_b32 s61, 0
K1_TL:
    s_mul_i32 s63, s51, 13108
    s_lshr_b32 s63, s63, 16
    s_mul_i32 s64, s63, 5
    s_sub_u32 s64, s51, s64
    s_lshr_b32 s67, s63, 1
    s_mul_i32 s67, s67, 20
    s_and_b32 s68, s63, 1
    s_lshl_b32 s68, s68, 2
    s_add_u32 s67, s67, s68
    s_add_u32 s68, s67, 8
    s_sub_u32 s65, s63, 64
    s_mul_i32 s65, s65, 40
    s_add_u32 s66, s65, 36
    s_add_u32 s65, s65, 16
    s_cmp_lt_u32 s63, 64
    s_cselect_b32 s67, s67, s65
    s_cselect_b32 s68, s68, s66
    s_sub_u32 s65, s63, 80
    s_lshr_b32 s66, s65, 2
    s_lshl_b32 s66, s66, 5
    s_and_b32 s65, s65, 3
    s_lshl_b32 s65, s65, 2
    s_add_u32 s65, s65, s66
    s_add_u32 s66, s65, 16
    s_cmp_lt_u32 s63, 80
    s_cselect_b32 s67, s67, s65
    s_cselect_b32 s68, s68, s66
    s_cselect_b32 s24, s8, s16
    s_cselect_b32 s25, s9, s17
    s_mov_b32 s26, 0x0021c000
    s_cselect_b32 s26, 0x000c8000, s26
    s_mov_b32 s27, 0x00020000
    s_mul_i32 s54, s67, 1280
    s_mul_i32 s55, s68, 1280
    s_lshl_b32 s65, s64, 8
    v_add_u32 v2, s65, v72
    buffer_load_dword v88, v2, s[24:27], s54 offen offset:0
    buffer_load_dword v89, v2, s[24:27], s54 offen offset:1280
    buffer_load_dword v90, v2, s[24:27], s54 offen offset:2560
    buffer_load_dword v91, v2, s[24:27], s54 offen offset:3840
    buffer_load_dword v92, v2, s[24:27], s55 offen offset:0
    buffer_load_dword v93, v2, s[24:27], s55 offen offset:1280
    buffer_load_dword v94, v2, s[24:27], s55 offen offset:2560
    buffer_load_dword v95, v2, s[24:27], s55 offen offset:3840
    s_mul_i32 s63, s63, 10240
    s_lshl_b32 s64, s64, 11
    s_add_u32 s63, s63, s64
    s_add_u32 s63, s63, 0x010e0000
    s_cmp_lt_u32 s51, 1480
    s_cselect_b32 s63, s63, 0x40000000
    v_add_u32 v6, s63, v73
    s_add_u32 s51, s51, 192
    s_mul_i32 s63, s51, 13108
    s_lshr_b32 s63, s63, 16
    s_mul_i32 s64, s63, 5
    s_sub_u32 s64, s51, s64
    s_lshr_b32 s67, s63, 1
    s_mul_i32 s67, s67, 20
    s_and_b32 s68, s63, 1
    s_lshl_b32 s68, s68, 2
    s_add_u32 s67, s67, s68
    s_add_u32 s68, s67, 8
    s_sub_u32 s65, s63, 64
    s_mul_i32 s65, s65, 40
    s_add_u32 s66, s65, 36
    s_add_u32 s65, s65, 16
    s_cmp_lt_u32 s63, 64
    s_cselect_b32 s67, s67, s65
    s_cselect_b32 s68, s68, s66
    s_sub_u32 s65, s63, 80
    s_lshr_b32 s66, s65, 2
    s_lshl_b32 s66, s66, 5
    s_and_b32 s65, s65, 3
    s_lshl_b32 s65, s65, 2
    s_add_u32 s65, s65, s66
    s_add_u32 s66, s65, 16
    s_cmp_lt_u32 s63, 80
    s_cselect_b32 s67, s67, s65
    s_cselect_b32 s68, s68, s66
    s_cselect_b32 s28, s8, s16
    s_cselect_b32 s29, s9, s17
    s_mov_b32 s30, 0x0021c000
    s_cselect_b32 s30, 0x000c8000, s30
    s_mov_b32 s31, 0x00020000
    s_mul_i32 s56, s67, 1280
    s_mul_i32 s57, s68, 1280
    s_lshl_b32 s65, s64, 8
    v_add_u32 v3, s65, v72
    buffer_load_dword v104, v3, s[28:31], s56 offen offset:0
    buffer_load_dword v105, v3, s[28:31], s56 offen offset:1280
    buffer_load_dword v106, v3, s[28:31], s56 offen offset:2560
    buffer_load_dword v107, v3, s[28:31], s56 offen offset:3840
    buffer_load_dword v108, v3, s[28:31], s57 offen offset:0
    buffer_load_dword v109, v3, s[28:31], s57 offen offset:1280
    buffer_load_dword v110, v3, s[28:31], s57 offen offset:2560
    buffer_load_dword v111, v3, s[28:31], s57 offen offset:3840
    s_mul_i32 s63, s63, 10240
    s_lshl_b32 s64, s64, 11
    s_add_u32 s63, s63, s64
    s_add_u32 s63, s63, 0x010e0000
    s_cmp_lt_u32 s51, 1480
    s_cselect_b32 s63, s63, 0x40000000
    v_add_u32 v7, s63, v73
    s_add_u32 s51, s51, 192
    s_mul_i32 s63, s51, 13108
    s_lshr_b32 s63, s63, 16
    s_mul_i32 s64, s63, 5
    s_sub_u32 s64, s51, s64
    s_lshr_b32 s67, s63, 1
    s_mul_i32 s67, s67, 20
    s_and_b32 s68, s63, 1
    s_lshl_b32 s68, s68, 2
    s_add_u32 s67, s67, s68
    s_add_u32 s68, s67, 8
    s_sub_u32 s65, s63, 64
    s_mul_i32 s65, s65, 40
    s_add_u32 s66, s65, 36
    s_add_u32 s65, s65, 16
    s_cmp_lt_u32 s63, 64
    s_cselect_b32 s67, s67, s65
    s_cselect_b32 s68, s68, s66
    s_sub_u32 s65, s63, 80
    s_lshr_b32 s66, s65, 2
    s_lshl_b32 s66, s66, 5
    s_and_b32 s65, s65, 3
    s_lshl_b32 s65, s65, 2
    s_add_u32 s65, s65, s66
    s_add_u32 s66, s65, 16
    s_cmp_lt_u32 s63, 80
    s_cselect_b32 s67, s67, s65
    s_cselect_b32 s68, s68, s66
    s_cselect_b32 s36, s8, s16
    s_cselect_b32 s37, s9, s17
    s_mov_b32 s38, 0x0021c000
    s_cselect_b32 s38, 0x000c8000, s38
    s_mov_b32 s39, 0x00020000
    s_mul_i32 s58, s67, 1280
    s_mul_i32 s59, s68, 1280
    s_lshl_b32 s65, s64, 8
    v_add_u32 v4, s65, v72
    buffer_load_dword v120, v4, s[36:39], s58 offen offset:0
    buffer_load_dword v121, v4, s[36:39], s58 offen offset:1280
    buffer_load_dword v122, v4, s[36:39], s58 offen offset:2560
    buffer_load_dword v123, v4, s[36:39], s58 offen offset:3840
    buffer_load_dword v124, v4, s[36:39], s59 offen offset:0
    buffer_load_dword v125, v4, s[36:39], s59 offen offset:1280
    buffer_load_dword v126, v4, s[36:39], s59 offen offset:2560
    buffer_load_dword v127, v4, s[36:39], s59 offen offset:3840
    s_mul_i32 s63, s63, 10240
    s_lshl_b32 s64, s64, 11
    s_add_u32 s63, s63, s64
    s_add_u32 s63, s63, 0x010e0000
    s_cmp_lt_u32 s51, 1480
    s_cselect_b32 s63, s63, 0x40000000
    v_add_u32 v8, s63, v73
    s_add_u32 s51, s51, 192
    s_mul_i32 s63, s51, 13108
    s_lshr_b32 s63, s63, 16
    s_mul_i32 s64, s63, 5
    s_sub_u32 s64, s51, s64
    s_lshr_b32 s67, s63, 1
    s_mul_i32 s67, s67, 20
    s_and_b32 s68, s63, 1
    s_lshl_b32 s68, s68, 2
    s_add_u32 s67, s67, s68
    s_add_u32 s68, s67, 8
    s_sub_u32 s65, s63, 64
    s_mul_i32 s65, s65, 40
    s_add_u32 s66, s65, 36
    s_add_u32 s65, s65, 16
    s_cmp_lt_u32 s63, 64
    s_cselect_b32 s67, s67, s65
    s_cselect_b32 s68, s68, s66
    s_sub_u32 s65, s63, 80
    s_lshr_b32 s66, s65, 2
    s_lshl_b32 s66, s66, 5
    s_and_b32 s65, s65, 3
    s_lshl_b32 s65, s65, 2
    s_add_u32 s65, s65, s66
    s_add_u32 s66, s65, 16
    s_cmp_lt_u32 s63, 80
    s_cselect_b32 s67, s67, s65
    s_cselect_b32 s68, s68, s66
    s_cselect_b32 s40, s8, s16
    s_cselect_b32 s41, s9, s17
    s_mov_b32 s42, 0x0021c000
    s_cselect_b32 s42, 0x000c8000, s42
    s_mov_b32 s43, 0x00020000
    s_mul_i32 s76, s67, 1280
    s_mul_i32 s77, s68, 1280
    s_lshl_b32 s65, s64, 8
    v_add_u32 v5, s65, v72
    buffer_load_dword v136, v5, s[40:43], s76 offen offset:0
    buffer_load_dword v137, v5, s[40:43], s76 offen offset:1280
    buffer_load_dword v138, v5, s[40:43], s76 offen offset:2560
    buffer_load_dword v139, v5, s[40:43], s76 offen offset:3840
    buffer_load_dword v140, v5, s[40:43], s77 offen offset:0
    buffer_load_dword v141, v5, s[40:43], s77 offen offset:1280
    buffer_load_dword v142, v5, s[40:43], s77 offen offset:2560
    buffer_load_dword v143, v5, s[40:43], s77 offen offset:3840
    s_mul_i32 s63, s63, 10240
    s_lshl_b32 s64, s64, 11
    s_add_u32 s63, s63, s64
    s_add_u32 s63, s63, 0x010e0000
    s_cmp_lt_u32 s51, 1480
    s_cselect_b32 s63, s63, 0x40000000
    v_add_u32 v9, s63, v73
    s_add_u32 s51, s51, 192
    s_waitcnt vmcnt(24)
    v_perm_b32 v96, v89, v88, s52
    v_perm_b32 v100, v89, v88, s53
    v_perm_b32 v97, v91, v90, s52
    v_perm_b32 v101, v91, v90, s53
    v_perm_b32 v98, v93, v92, s52
    v_perm_b32 v102, v93, v92, s53
    v_perm_b32 v99, v95, v94, s52
    v_perm_b32 v103, v95, v94, s53
    ds_write_b128 v10, v[96:99] offset:0
    ds_write_b128 v10, v[100:103] offset:16
    s_waitcnt vmcnt(16)
    v_perm_b32 v112, v105, v104, s52
    v_perm_b32 v116, v105, v104, s53
    v_perm_b32 v113, v107, v106, s52
    v_perm_b32 v117, v107, v106, s53
    v_perm_b32 v114, v109, v108, s52
    v_perm_b32 v118, v109, v108, s53
    v_perm_b32 v115, v111, v110, s52
    v_perm_b32 v119, v111, v110, s53
    ds_write_b128 v10, v[112:115] offset:2048
    ds_write_b128 v10, v[116:119] offset:2064
    s_waitcnt vmcnt(8)
    v_perm_b32 v128, v121, v120, s52
    v_perm_b32 v132, v121, v120, s53
    v_perm_b32 v129, v123, v122, s52
    v_perm_b32 v133, v123, v122, s53
    v_perm_b32 v130, v125, v124, s52
    v_perm_b32 v134, v125, v124, s53
    v_perm_b32 v131, v127, v126, s52
    v_perm_b32 v135, v127, v126, s53
    ds_write_b128 v10, v[128:131] offset:4096
    ds_write_b128 v10, v[132:135] offset:4112
    s_waitcnt vmcnt(0)
    v_perm_b32 v144, v137, v136, s52
    v_perm_b32 v148, v137, v136, s53
    v_perm_b32 v145, v139, v138, s52
    v_perm_b32 v149, v139, v138, s53
    v_perm_b32 v146, v141, v140, s52
    v_perm_b32 v150, v141, v140, s53
    v_perm_b32 v147, v143, v142, s52
    v_perm_b32 v151, v143, v142, s53
    ds_write_b128 v10, v[144:147] offset:6144
    ds_write_b128 v10, v[148:151] offset:6160
    s_waitcnt lgkmcnt(0)
    ds_read_b128 v[96:99], v11 offset:0
    ds_read_b128 v[100:103], v11 offset:1024
    ds_read_b128 v[112:115], v11 offset:2048
    ds_read_b128 v[116:119], v11 offset:3072
    ds_read_b128 v[128:131], v11 offset:4096
    ds_read_b128 v[132:135], v11 offset:5120
    ds_read_b128 v[144:147], v11 offset:6144
    ds_read_b128 v[148:151], v11 offset:7168
    s_waitcnt lgkmcnt(6)
    buffer_store_dwordx4 v[96:99], v6, s[32:35], 0 offen sc1
    buffer_store_dwordx4 v[100:103], v6, s[32:35], 0 offen offset:1024 sc1
    s_waitcnt lgkmcnt(4)
    buffer_store_dwordx4 v[112:115], v7, s[32:35], 0 offen sc1
    buffer_store_dwordx4 v[116:119], v7, s[32:35], 0 offen offset:1024 sc1
    s_waitcnt lgkmcnt(2)
    buffer_store_dwordx4 v[128:131], v8, s[32:35], 0 offen sc1
    buffer_store_dwordx4 v[132:135], v8, s[32:35], 0 offen offset:1024 sc1
    s_waitcnt lgkmcnt(0)
    buffer_store_dwordx4 v[144:147], v9, s[32:35], 0 offen sc1
    buffer_store_dwordx4 v[148:151], v9, s[32:35], 0 offen offset:1024 sc1
    s_add_u32 s61, s61, 1
    s_cmp_lt_u32 s61, 2
    s_cbranch_scc1 K1_TL
    s_waitcnt vmcnt(0)
    s_barrier
    s_cmp_lg_u32 s44, 0
    s_cbranch_scc1 P2_ENTRY
    s_mov_b32 s20, s10
    s_mov_b32 s21, s11
    s_mov_b32 s22, 0x00000100
    s_mov_b32 s23, 0x00020000
    v_mov_b32 v22, 0
    s_mov_b32 s69, 0
ZP_tr:
    buffer_load_dword v23, v22, s[20:23], 0 offen sc1
    s_add_u32 s69, s69, 1
    s_waitcnt vmcnt(0)
    v_readfirstlane_b32 s68, v23
    s_cmp_ge_u32 s69, 2097152
    s_cbranch_scc1 ZD_tr
    s_cmp_eq_u32 s68, 0
    s_cbranch_scc1 ZP_tr
ZD_tr:
    v_lshlrev_b32 v22, 11, v1
    s_lshl_b32 s63, s47, 2
    s_add_u32 s63, s63, 0x013c4b80
    s_mov_b64 exec, 15
    buffer_store_dword v21, v22, s[32:35], s63 offen sc1
    s_mov_b64 exec, -1
    s_branch P2_ENTRY
K1_END:
    s_endpgm
.p2align 6
P2_ENTRY:
    s_load_dwordx2 s[4:5], s[0:1], 80
    s_load_dwordx2 s[6:7], s[0:1], 0
    s_load_dwordx2 s[8:9], s[0:1], 56
    s_load_dwordx4 s[60:63], s[0:1], 64
    v_and_b32 v1, 63, v0
    v_lshrrev_b32 v6, 6, v0
    s_and_b32 s28, s2, 7
    v_readfirstlane_b32 s20, v6
    s_lshr_b32 s29, s2, 3
    s_lshl_b32 s30, s28, 2
    s_and_b32 s31, s29, 3
    s_add_u32 s21, s30, s31
    v_lshlrev_b32 v2, 4, v1
    s_mul_i32 s30, s21, 167936
    s_add_u32 s30, s30, 0x00280000
    s_waitcnt lgkmcnt(0)
    s_add_u32 s16, s4, s30
    s_addc_u32 s17, s5, 0
    s_mov_b32 s18, 167936
    s_mov_b32 s19, 0x00020000
    v_mov_b32 v11, 153608
    s_cmp_lg_u32 s20, 0
    s_cbranch_scc1 P2_SPIN
    s_add_u32 s64, s4, 0x013c4000
    s_addc_u32 s65, s5, 0
    s_mov_b32 s66, 0x00003000
    s_mov_b32 s67, 0x00020000
    s_mul_i32 s30, s21, 20
    s_and_b32 s31, s2, 3
    s_lshl_b32 s31, s31, 11
    s_add_u32 s31, s31, 1024
    v_lshrrev_b32 v6, 5, v1
    v_mul_u32_u24 v6, 640, v6
    v_bfe_u32 v7, v1, 4, 1
    v_mul_u32_u24 v7, 19, v7
    v_add3_u32 v6, v6, v7, s30
    v_add_u32 v6, 640, v6
    v_and_b32 v6, 0xffffff80, v6
    v_and_b32 v7, 15, v1
    v_lshl_add_u32 v6, v7, 2, v6
    v_add_u32 v6, s31, v6
    v_and_b32 v8, 1, v1
    v_mul_u32_u24 v8, 19, v8
    v_add_u32 v8, s30, v8
    v_and_b32 v8, 0xffffff80, v8
    v_bfe_u32 v9, v1, 1, 1
    s_lshr_b32 s30, s2, 5
    s_lshl_b32 s30, s30, 1
    v_add_u32 v9, s30, v9
    v_lshl_add_u32 v8, v9, 2, v8
    v_lshlrev_b32 v9, 2, v7
    v_add_u32 v9, 1920, v9
    v_cmp_gt_u32 vcc, 16, v1
    s_nop 1
    v_cndmask_b32 v8, v8, v9, vcc
    v_add_u32 v8, s31, v8
    s_mov_b32 s24, 0
GP_go:
    buffer_load_dword v10, v6, s[64:67], 0 offen sc1
    buffer_load_dword v9, v8, s[64:67], 0 offen sc1
    s_add_u32 s24, s24, 1
    s_waitcnt vmcnt(0)
    v_and_b32 v10, v10, v9
    v_cmp_ne_u32 vcc, 1, v10
    s_cmp_ge_u32 s24, 2097152
    s_cbranch_scc1 GD_go
    s_cbranch_vccz GD_go
    s_sleep 3
    s_branch GP_go
GD_go:
    v_mov_b32 v10, 1
    ds_write_b32 v11, v10
    s_branch P2_GO
P2_SPIN:
    ds_read_b32 v10, v11
    s_waitcnt lgkmcnt(0)
    v_readfirstlane_b32 s30, v10
    s_cmp_eq_u32 s30, 1
    s_cbranch_scc1 P2_GO
    s_sleep 1
    s_branch P2_SPIN
P2_GO:
    s_cmp_ge_u32 s20, 4
    s_cbranch_scc1 K2_ATT
    s_setprio 3
    s_and_b32 s30, s20, 1
    s_lshr_b32 s31, s20, 1
    s_lshl_b32 s31, s31, 10
    s_mul_i32 s23, s30, 83968
    s_add_u32 s23, s23, s31
    s_mul_i32 s26, s30, 81920
    s_add_u32 s26, s26, s31
    s_add_u32 m0, s26, 78720
    s_add_u32 s30, s23, 80000
    buffer_load_dwordx4 v2, s[16:19], s30 offen sc1 lds
    s_cmp_eq_u32 s31, 0
    s_cselect_b32 exec_hi, 0xff, 0
    s_cselect_b32 exec_lo, -1, 1
    s_cselect_b32 s32, 2048, 0
    s_add_u32 s30, s30, s32
    s_add_u32 s32, s32, s26
    s_add_u32 m0, s32, 78720
    s_nop 0
    buffer_load_dwordx4 v2, s[16:19], s30 offen sc1 lds
    s_mov_b64 exec, -1
    s_mov_b32 m0, s26
    s_add_u32 s26, s26, 2048
    buffer_load_dwordx4 v2, s[16:19], s23 offen sc1 lds
    s_add_u32 s23, s23, 2048
    s_mov_b32 m0, s26
    s_add_u32 s26, s26, 2048
    buffer_load_dwordx4 v2, s[16:19], s23 offen sc1 lds
    s_add_u32 s23, s23, 2048
    s_mov_b32 m0, s26
    s_add_u32 s26, s26, 2048
    buffer_load_dwordx4 v2, s[16:19], s23 offen sc1 lds
    s_add_u32 s23, s23, 2048
    s_mov_b32 m0, s26
    s_add_u32 s26, s26, 2048
    buffer_load_dwordx4 v2, s[16:19], s23 offen sc1 lds
    s_add_u32 s23, s23, 2048
    s_mov_b32 m0, s26
    s_add_u32 s26, s26, 2048
    buffer_load_dwordx4 v2, s[16:19], s23 offen sc1 lds
    s_add_u32 s23, s23, 2048
    s_mov_b32 m0, s26
    s_add_u32 s26, s26, 2048
    buffer_load_dwordx4 v2, s[16:19], s23 offen sc1 lds
    s_add_u32 s23, s23, 2048
    s_lshl_b32 s28, s28, 2
    s_and_b32 s30, s29, 3
    s_add_u32 s56, s28, s30
    s_lshr_b32 s57, s29, 2
    s_add_u32 s36, s4, 0x00a20000
    s_addc_u32 s37, s5, 0
    s_mov_b32 s38, 0x006c0000
    s_mov_b32 s39, 0x00020000
    s_add_u32 s40, s4, 0x011a8000
    s_addc_u32 s41, s5, 0
    s_mov_b32 s42, 0x0021c000
    s_mov_b32 s43, 0x00020000
    s_mov_b32 s44, s6
    s_mov_b32 s45, s7
    s_mov_b32 s46, 0x00280000
    s_mov_b32 s47, 0x00020000
    s_mov_b32 s48, s8
    s_mov_b32 s49, s9
    s_mov_b32 s50, 0x00000500
    s_mov_b32 s51, 0x00020000
    v_and_b32 v6, 15, v1
    v_lshrrev_b32 v7, 4, v1
    s_lshl_b32 s28, s56, 6
    v_add_u32 v8, s28, v6
    v_lshlrev_b32 v3, 4, v8
    v_lshl_add_u32 v3, v7, 15, v3
    s_mul_i32 s29, s57, 80
    v_add_u32 v9, s29, v6
    v_lshlrev_b32 v4, 4, v9
    v_mul_u32_u24 v9, 10240, v7
    v_add_u32 v4, v4, v9
    s_lshl_b32 s58, s20, 17
    s_mul_i32 s59, s20, 40960
    v_lshlrev_b32 v12, 3, v7
    s_lshl_b32 s30, s29, 1
    v_add_u32 v12, s30, v12
    s_lshl_b32 s30, s20, 4
    v_add_u32 v8, s30, v8
    v_mul_u32_u24 v5, 1280, v8
    v_add_u32 v5, v5, v12
    s_lshl_b32 s28, s56, 3
    s_add_u32 s28, s28, s57
    s_mul_i32 s28, s28, 20480
    s_mul_i32 s30, s20, 5120
    s_add_u32 s28, s28, s30
    v_add_u32 v13, s28, v2
    v_mov_b32 v88, 0
    v_mov_b32 v89, 0
    v_mov_b32 v90, 0
    v_mov_b32 v91, 0
    v_mov_b32 v92, 0
    v_mov_b32 v93, 0
    v_mov_b32 v94, 0
    v_mov_b32 v95, 0
    v_mov_b32 v96, 0
    v_mov_b32 v97, 0
    v_mov_b32 v98, 0
    v_mov_b32 v99, 0
    v_mov_b32 v100, 0
    v_mov_b32 v101, 0
    v_mov_b32 v102, 0
    v_mov_b32 v103, 0
    v_mov_b32 v104, 0
    v_mov_b32 v105, 0
    v_mov_b32 v106, 0
    v_mov_b32 v107, 0
    v_mov_b32 v108, 0
    v_mov_b32 v109, 0
    v_mov_b32 v110, 0
    v_mov_b32 v111, 0
    v_mov_b32 v112, 0
    v_mov_b32 v113, 0
    v_mov_b32 v114, 0
    v_mov_b32 v115, 0
    v_mov_b32 v116, 0
    v_mov_b32 v117, 0
    v_mov_b32 v118, 0
    v_mov_b32 v119, 0
    v_mov_b32 v120, 0
    v_mov_b32 v121, 0
    v_mov_b32 v122, 0
    v_mov_b32 v123, 0
    v_mov_b32 v124, 0
    v_mov_b32 v125, 0
    v_mov_b32 v126, 0
    v_mov_b32 v127, 0
    v_mov_b32 v128, 0
    v_mov_b32 v129, 0
    v_mov_b32 v130, 0
    v_mov_b32 v131, 0
    v_mov_b32 v132, 0
    v_mov_b32 v133, 0
    v_mov_b32 v134, 0
    v_mov_b32 v135, 0
    v_mov_b32 v136, 0
    v_mov_b32 v137, 0
    v_mov_b32 v138, 0
    v_mov_b32 v139, 0
    v_mov_b32 v140, 0
    v_mov_b32 v141, 0
    v_mov_b32 v142, 0
    v_mov_b32 v143, 0
    v_mov_b32 v144, 0
    v_mov_b32 v145, 0
    v_mov_b32 v146, 0
    v_mov_b32 v147, 0
    v_mov_b32 v148, 0
    v_mov_b32 v149, 0
    v_mov_b32 v150, 0
    v_mov_b32 v151, 0
    v_mov_b32 v152, 0
    v_mov_b32 v153, 0
    v_mov_b32 v154, 0
    v_mov_b32 v155, 0
    v_mov_b32 v156, 0
    v_mov_b32 v157, 0
    v_mov_b32 v158, 0
    v_mov_b32 v159, 0
    v_mov_b32 v160, 0
    v_mov_b32 v161, 0
    v_mov_b32 v162, 0
    v_mov_b32 v163, 0
    v_mov_b32 v164, 0
    v_mov_b32 v165, 0
    v_mov_b32 v166, 0
    v_mov_b32 v167, 0
    s_mov_b32 s24, 0
    s_mov_b32 s32, 0x00000002
    v_mov_b32 v6, 0
    s_waitcnt vmcnt(6)
    s_barrier
    v_mov_b32 v48, 0x40000000
    v_mov_b32 v49, 0x40000000
    s_cmp_eq_u32 s72, 0
    s_cbranch_scc1 K2_NOHR
    s_mul_i32 s30, s20, 8704
    s_add_u32 s30, s30, 114688
    v_add_u32 v7, s30, v2
    ds_read_b128 v[16:19], v7 offset:0
    ds_read_b128 v[20:23], v7 offset:1024
    ds_read_b128 v[24:27], v7 offset:2048
    ds_read_b128 v[28:31], v7 offset:3072
    ds_read_b128 v[32:35], v7 offset:4096
    ds_read_b128 v[36:39], v7 offset:5120
    ds_read_b128 v[40:43], v7 offset:6144
    ds_read_b128 v[44:47], v7 offset:7168
    v_lshlrev_b32 v7, 3, v1
    v_add_u32 v7, s30, v7
    ds_read_b64 v[48:49], v7 offset:8192
K2_NOHR:
    s_mov_b32 m0, s26
    s_add_u32 s26, s26, 2048
    buffer_load_dwordx4 v2, s[16:19], s23 offen sc1 lds
    s_add_u32 s23, s23, 2048
    s_mov_b32 m0, s26
    s_add_u32 s26, s26, 2048
    buffer_load_dwordx4 v2, s[16:19], s23 offen sc1 lds
    s_add_u32 s23, s23, 2048
    s_mov_b32 m0, s26
    s_add_u32 s26, s26, 2048
    buffer_load_dwordx4 v2, s[16:19], s23 offen sc1 lds
    s_add_u32 s23, s23, 2048
    s_mov_b32 m0, s26
    s_add_u32 s26, s26, 2048
    buffer_load_dwordx4 v2, s[16:19], s23 offen sc1 lds
    s_add_u32 s23, s23, 2048
    s_mov_b32 m0, s26
    s_add_u32 s26, s26, 2048
    buffer_load_dwordx4 v2, s[16:19], s23 offen sc1 lds
    s_add_u32 s23, s23, 2048
    s_mov_b32 m0, s26
    s_add_u32 s26, s26, 2048
    buffer_load_dwordx4 v2, s[16:19], s23 offen sc1 lds
    s_add_u32 s23, s23, 2048
    s_mov_b32 m0, s26
    s_add_u32 s26, s26, 2048
    buffer_load_dwordx4 v2, s[16:19], s23 offen sc1 lds
    s_add_u32 s23, s23, 2048
    s_mov_b32 m0, s26
    s_add_u32 s26, s26, 2048
    buffer_load_dwordx4 v2, s[16:19], s23 offen sc1 lds
    s_add_u32 s23, s23, 2048
    s_mov_b32 m0, s26
    s_add_u32 s26, s26, 2048
    buffer_load_dwordx4 v2, s[16:19], s23 offen sc1 lds
    s_add_u32 s23, s23, 2048
    s_mov_b32 m0, s26
    s_add_u32 s26, s26, 2048
    buffer_load_dwordx4 v2, s[16:19], s23 offen sc1 lds
    s_add_u32 s23, s23, 2048
    s_waitcnt vmcnt(10) lgkmcnt(0)
    s_barrier
    s_mov_b32 m0, s26
    s_add_u32 s26, s26, 2048
    buffer_load_dwordx4 v2, s[16:19], s23 offen sc1 lds
    s_add_u32 s23, s23, 2048
    s_mov_b32 m0, s26
    s_add_u32 s26, s26, 2048
    buffer_load_dwordx4 v2, s[16:19], s23 offen sc1 lds
    s_add_u32 s23, s23, 2048
    s_mov_b32 m0, s26
    s_add_u32 s26, s26, 2048
    buffer_load_dwordx4 v2, s[16:19], s23 offen sc1 lds
    s_add_u32 s23, s23, 2048
    s_mov_b32 m0, s26
    s_add_u32 s26, s26, 2048
    buffer_load_dwordx4 v2, s[16:19], s23 offen sc1 lds
    s_add_u32 s23, s23, 2048
    s_mov_b32 m0, s26
    s_add_u32 s26, s26, 2048
    buffer_load_dwordx4 v2, s[16:19], s23 offen sc1 lds
    s_add_u32 s23, s23, 2048
    s_mov_b32 m0, s26
    s_add_u32 s26, s26, 2048
    buffer_load_dwordx4 v2, s[16:19], s23 offen sc1 lds
    s_add_u32 s23, s23, 2048
    s_mov_b32 m0, s26
    s_add_u32 s26, s26, 2048
    buffer_load_dwordx4 v2, s[16:19], s23 offen sc1 lds
    s_add_u32 s23, s23, 2048
    s_mov_b32 m0, s26
    s_add_u32 s26, s26, 2048
    buffer_load_dwordx4 v2, s[16:19], s23 offen sc1 lds
    s_add_u32 s23, s23, 2048
    s_mov_b32 m0, s26
    s_add_u32 s26, s26, 2048
    buffer_load_dwordx4 v2, s[16:19], s23 offen sc1 lds
    s_add_u32 s23, s23, 2048
    s_mov_b32 m0, s26
    s_add_u32 s26, s26, 2048
    buffer_load_dwordx4 v2, s[16:19], s23 offen sc1 lds
    s_add_u32 s23, s23, 2048
    s_mov_b32 m0, s26
    s_add_u32 s26, s26, 2048
    buffer_load_dwordx4 v2, s[16:19], s23 offen sc1 lds
    s_add_u32 s23, s23, 2048
    s_mov_b32 m0, s26
    s_add_u32 s26, s26, 2048
    buffer_load_dwordx4 v2, s[16:19], s23 offen sc1 lds
    s_add_u32 s23, s23, 2048
    s_mov_b32 m0, s26
    s_add_u32 s26, s26, 2048
    buffer_load_dwordx4 v2, s[16:19], s23 offen sc1 lds
    s_add_u32 s23, s23, 2048
    s_mov_b32 m0, s26
    s_add_u32 s26, s26, 2048
    buffer_load_dwordx4 v2, s[16:19], s23 offen sc1 lds
    s_add_u32 s23, s23, 2048
    s_mov_b32 m0, s26
    s_add_u32 s26, s26, 2048
    buffer_load_dwordx4 v2, s[16:19], s23 offen sc1 lds
    s_add_u32 s23, s23, 2048
    s_mov_b32 m0, s26
    s_add_u32 s26, s26, 2048
    buffer_load_dwordx4 v2, s[16:19], s23 offen sc1 lds
    s_add_u32 s23, s23, 2048
    s_mov_b32 m0, s26
    s_add_u32 s26, s26, 2048
    buffer_load_dwordx4 v2, s[16:19], s23 offen sc1 lds
    s_add_u32 s23, s23, 2048
    s_mov_b32 m0, s26
    s_add_u32 s26, s26, 2048
    buffer_load_dwordx4 v2, s[16:19], s23 offen sc1 lds
    s_add_u32 s23, s23, 2048
    s_mov_b32 m0, s26
    s_add_u32 s26, s26, 2048
    buffer_load_dwordx4 v2, s[16:19], s23 offen sc1 lds
    s_add_u32 s23, s23, 2048
    s_mov_b32 m0, s26
    s_add_u32 s26, s26, 2048
    buffer_load_dwordx4 v2, s[16:19], s23 offen sc1 lds
    s_add_u32 s23, s23, 2048
    s_mov_b32 m0, s26
    s_add_u32 s26, s26, 2048
    buffer_load_dwordx4 v2, s[16:19], s23 offen sc1 lds
    s_add_u32 s23, s23, 2048
    s_mov_b32 m0, s26
    s_add_u32 s26, s26, 2048
    buffer_load_dwordx4 v2, s[16:19], s23 offen sc1 lds
    s_add_u32 s23, s23, 2048
    s_lshr_b32 s31, s20, 1
    s_cmp_eq_u32 s31, 0
    s_cselect_b32 exec_hi, 0xffffff, 0
    s_cselect_b32 exec_lo, -1, 1
    s_cselect_b32 s31, 0, 2048
    s_sub_u32 s26, s26, s31
    s_sub_u32 s23, s23, s31
    s_mov_b32 m0, s26
    s_add_u32 s26, s26, 2048
    buffer_load_dwordx4 v2, s[16:19], s23 offen sc1 lds
    s_add_u32 s23, s23, 2048
    s_mov_b64 exec, -1
    s_waitcnt vmcnt(29)
    s_barrier
    s_mov_b32 s12, s4
    s_mov_b32 s13, s5
    s_mov_b32 s14, 0x013cb000
    s_mov_b32 s15, 0x00020000
    buffer_store_dwordx4 v[16:19], v49, s[12:15], 0 offen offset:0 sc1
    buffer_store_dwordx4 v[20:23], v49, s[12:15], 0 offen offset:256 sc1
    buffer_store_dwordx4 v[24:27], v49, s[12:15], 0 offen offset:512 sc1
    buffer_store_dwordx4 v[28:31], v49, s[12:15], 0 offen offset:768 sc1
    buffer_store_dwordx4 v[32:35], v48, s[12:15], 0 offen offset:0 sc1
    buffer_store_dwordx4 v[36:39], v48, s[12:15], 0 offen offset:256 sc1
    buffer_store_dwordx4 v[40:43], v48, s[12:15], 0 offen offset:512 sc1
    buffer_store_dwordx4 v[44:47], v48, s[12:15], 0 offen offset:768 sc1
    s_add_u32 s64, s4, 0x013c4000
    s_addc_u32 s65, s5, 0
    s_mov_b32 s66, 0x00003000
    s_mov_b32 s67, 0x00020000
    v_min_u32 v7, 13, v1
    v_lshlrev_b32 v7, 2, v7
    s_lshr_b32 s30, s56, 1
    s_lshl_b32 s30, s30, 7
    s_add_u32 s30, s30, 9216
    v_add_u32 v7, s30, v7
    s_waitcnt vmcnt(0)
    s_barrier
    s_cmp_lg_u32 s20, 0
    s_cbranch_scc1 K2_NOHF
    s_cmp_eq_u32 s72, 0
    s_cbranch_scc1 K2_NOHF
    v_mov_b32 v10, 1
    s_mov_b64 exec, 1
    buffer_store_dword v10, v6, s[64:67], s72 offen sc1
K2_NOHF:
    s_mov_b64 exec, 0xffff
    s_mov_b32 s24, 0
GP_h:
    buffer_load_dword v10, v7, s[64:67], 0 offen sc1
    s_add_u32 s24, s24, 1
    s_waitcnt vmcnt(0)
    v_cmp_ne_u32 vcc, 1, v10
    s_cmp_ge_u32 s24, 2097152
    s_cbranch_scc1 GD_h
    s_cbranch_vccz GD_h
    s_sleep 3
    s_branch GP_h
GD_h:
    s_mov_b64 exec, -1
    s_mov_b32 s24, 0
    buffer_load_dwordx4 v[16:19], v3, s[36:39], s58 offen offset:0 sc1
    buffer_load_dwordx4 v[20:23], v3, s[36:39], s58 offen offset:256 sc1
    buffer_load_dwordx4 v[24:27], v3, s[36:39], s58 offen offset:512 sc1
    buffer_load_dwordx4 v[28:31], v3, s[36:39], s58 offen offset:768 sc1
    buffer_load_dwordx4 v[32:35], v4, s[40:43], s59 offen offset:0 sc1
    buffer_load_dwordx4 v[36:39], v4, s[40:43], s59 offen offset:256 sc1
    buffer_load_dwordx4 v[40:43], v4, s[40:43], s59 offen offset:512 sc1
    buffer_load_dwordx4 v[44:47], v4, s[40:43], s59 offen offset:768 sc1
    buffer_load_dwordx4 v[48:51], v4, s[40:43], s59 offen offset:1024 sc1
    s_add_u32 s58, s58, 524288
    s_add_u32 s59, s59, 163840
    buffer_load_dwordx4 v[52:55], v3, s[36:39], s58 offen offset:0 sc1
    buffer_load_dwordx4 v[56:59], v3, s[36:39], s58 offen offset:256 sc1
    buffer_load_dwordx4 v[60:63], v3, s[36:39], s58 offen offset:512 sc1
    buffer_load_dwordx4 v[64:67], v3, s[36:39], s58 offen offset:768 sc1
    buffer_load_dwordx4 v[68:71], v4, s[40:43], s59 offen offset:0 sc1
    buffer_load_dwordx4 v[72:75], v4, s[40:43], s59 offen offset:256 sc1
    buffer_load_dwordx4 v[76:79], v4, s[40:43], s59 offen offset:512 sc1
    buffer_load_dwordx4 v[80:83], v4, s[40:43], s59 offen offset:768 sc1
    buffer_load_dwordx4 v[84:87], v4, s[40:43], s59 offen offset:1024 sc1
    s_add_u32 s58, s58, 524288
    s_add_u32 s59, s59, 163840
    s_setprio 0
.p2align 3
K2_GL:
    s_waitcnt vmcnt(9)
    v_mfma_f32_16x16x32_bf16 v[88:91], v[32:35], v[16:19], v[88:91]
    v_mfma_f32_16x16x32_bf16 v[108:111], v[32:35], v[20:23], v[108:111]
    v_mfma_f32_16x16x32_bf16 v[128:131], v[32:35], v[24:27], v[128:131]
    v_mfma_f32_16x16x32_bf16 v[148:151], v[32:35], v[28:31], v[148:151]
    buffer_load_dwordx4 v[32:35], v4, s[40:43], s59 offen offset:0 sc1
    v_mfma_f32_16x16x32_bf16 v[92:95], v[36:39], v[16:19], v[92:95]
    v_mfma_f32_16x16x32_bf16 v[112:115], v[36:39], v[20:23], v[112:115]
    v_mfma_f32_16x16x32_bf16 v[132:135], v[36:39], v[24:27], v[132:135]
    v_mfma_f32_16x16x32_bf16 v[152:155], v[36:39], v[28:31], v[152:155]
    buffer_load_dwordx4 v[36:39], v4, s[40:43], s59 offen offset:256 sc1
    v_mfma_f32_16x16x32_bf16 v[96:99], v[40:43], v[16:19], v[96:99]
    v_mfma_f32_16x16x32_bf16 v[116:119], v[40:43], v[20:23], v[116:119]
    v_mfma_f32_16x16x32_bf16 v[136:139], v[40:43], v[24:27], v[136:139]
    v_mfma_f32_16x16x32_bf16 v[156:159], v[40:43], v[28:31], v[156:159]
    buffer_load_dwordx4 v[40:43], v4, s[40:43], s59 offen offset:512 sc1
    v_mfma_f32_16x16x32_bf16 v[100:103], v[44:47], v[16:19], v[100:103]
    v_mfma_f32_16x16x32_bf16 v[120:123], v[44:47], v[20:23], v[120:123]
    v_mfma_f32_16x16x32_bf16 v[140:143], v[44:47], v[24:27], v[140:143]
    v_mfma_f32_16x16x32_bf16 v[160:163], v[44:47], v[28:31], v[160:163]
    buffer_load_dwordx4 v[44:47], v4, s[40:43], s59 offen offset:768 sc1
    v_mfma_f32_16x16x32_bf16 v[104:107], v[48:51], v[16:19], v[104:107]
    buffer_load_dwordx4 v[16:19], v3, s[36:39], s58 offen offset:0 sc1
    v_mfma_f32_16x16x32_bf16 v[124:127], v[48:51], v[20:23], v[124:127]
    buffer_load_dwordx4 v[20:23], v3, s[36:39], s58 offen offset:256 sc1
    v_mfma_f32_16x16x32_bf16 v[144:147], v[48:51], v[24:27], v[144:147]
    buffer_load_dwordx4 v[24:27], v3, s[36:39], s58 offen offset:512 sc1
    v_mfma_f32_16x16x32_bf16 v[164:167], v[48:51], v[28:31], v[164:167]
    buffer_load_dwordx4 v[28:31], v3, s[36:39], s58 offen offset:768 sc1
    buffer_load_dwordx4 v[48:51], v4, s[40:43], s59 offen offset:1024 sc1
    s_add_u32 s58, s58, 524288
    s_add_u32 s59, s59, 163840
    s_waitcnt vmcnt(9)
    v_mfma_f32_16x16x32_bf16 v[88:91], v[68:71], v[52:55], v[88:91]
    v_mfma_f32_16x16x32_bf16 v[108:111], v[68:71], v[56:59], v[108:111]
    v_mfma_f32_16x16x32_bf16 v[128:131], v[68:71], v[60:63], v[128:131]
    v_mfma_f32_16x16x32_bf16 v[148:151], v[68:71], v[64:67], v[148:151]
    buffer_load_dwordx4 v[68:71], v4, s[40:43], s59 offen offset:0 sc1
    v_mfma_f32_16x16x32_bf16 v[92:95], v[72:75], v[52:55], v[92:95]
    v_mfma_f32_16x16x32_bf16 v[112:115], v[72:75], v[56:59], v[112:115]
    v_mfma_f32_16x16x32_bf16 v[132:135], v[72:75], v[60:63], v[132:135]
    v_mfma_f32_16x16x32_bf16 v[152:155], v[72:75], v[64:67], v[152:155]
    buffer_load_dwordx4 v[72:75], v4, s[40:43], s59 offen offset:256 sc1
    v_mfma_f32_16x16x32_bf16 v[96:99], v[76:79], v[52:55], v[96:99]
    v_mfma_f32_16x16x32_bf16 v[116:119], v[76:79], v[56:59], v[116:119]
    v_mfma_f32_16x16x32_bf16 v[136:139], v[76:79], v[60:63], v[136:139]
    v_mfma_f32_16x16x32_bf16 v[156:159], v[76:79], v[64:67], v[156:159]
    buffer_load_dwordx4 v[76:79], v4, s[40:43], s59 offen offset:512 sc1
    v_mfma_f32_16x16x32_bf16 v[100:103], v[80:83], v[52:55], v[100:103]
    v_mfma_f32_16x16x32_bf16 v[120:123], v[80:83], v[56:59], v[120:123]
    v_mfma_f32_16x16x32_bf16 v[140:143], v[80:83], v[60:63], v[140:143]
    v_mfma_f32_16x16x32_bf16 v[160:163], v[80:83], v[64:67], v[160:163]
    buffer_load_dwordx4 v[80:83], v4, s[40:43], s59 offen offset:768 sc1
    v_mfma_f32_16x16x32_bf16 v[104:107], v[84:87], v[52:55], v[104:107]
    buffer_load_dwordx4 v[52:55], v3, s[36:39], s58 offen offset:0 sc1
    v_mfma_f32_16x16x32_bf16 v[124:127], v[84:87], v[56:59], v[124:127]
    buffer_load_dwordx4 v[56:59], v3, s[36:39], s58 offen offset:256 sc1
    v_mfma_f32_16x16x32_bf16 v[144:147], v[84:87], v[60:63], v[144:147]
    buffer_load_dwordx4 v[60:63], v3, s[36:39], s58 offen offset:512 sc1
    v_mfma_f32_16x16x32_bf16 v[164:167], v[84:87], v[64:67], v[164:167]
    buffer_load_dwordx4 v[64:67], v3, s[36:39], s58 offen offset:768 sc1
    buffer_load_dwordx4 v[84:87], v4, s[40:43], s59 offen offset:1024 sc1
    s_add_u32 s58, s58, 524288
    s_add_u32 s59, s59, 163840
    s_add_u32 s24, s24, 1
    s_cmp_lt_u32 s24, 7
    s_cbranch_scc1 K2_GL
    s_setprio 3
    s_waitcnt vmcnt(0)
    buffer_load_dwordx2 v[68:69], v5, s[44:47], 0 offen offset:0
    buffer_load_dwordx2 v[78:79], v12, s[48:51], 0 offen offset:0
    buffer_load_dwordx2 v[70:71], v5, s[44:47], 0 offen offset:32
    buffer_load_dwordx2 v[80:81], v12, s[48:51], 0 offen offset:32
    buffer_load_dwordx2 v[72:73], v5, s[44:47], 0 offen offset:64
    buffer_load_dwordx2 v[82:83], v12, s[48:51], 0 offen offset:64
    buffer_load_dwordx2 v[74:75], v5, s[44:47], 0 offen offset:96
    buffer_load_dwordx2 v[84:85], v12, s[48:51], 0 offen offset:96
    buffer_load_dwordx2 v[76:77], v5, s[44:47], 0 offen offset:128
    buffer_load_dwordx2 v[86:87], v12, s[48:51], 0 offen offset:128
    s_add_u32 s40, s4, 0x010e0000
    s_addc_u32 s41, s5, 0
    s_mov_b32 s42, 0x000c8000
    s_mov_b32 s43, 0x00020000
    s_add_u32 s36, s4, 0x007a0000
    s_addc_u32 s37, s5, 0
    s_mov_b32 s38, 0x00280000
    s_mov_b32 s39, 0x00020000
    s_mov_b32 s52, s60
    s_mov_b32 s53, s61
    s_mov_b32 s54, 0x00280000
    s_mov_b32 s55, 0x00020000
    s_add_u32 s64, s4, 0x013c4000
    s_addc_u32 s65, s5, 0
    s_mov_b32 s66, 0x00003000
    s_mov_b32 s67, 0x00020000
    s_mul_i32 s59, s20, 204800
    s_lshr_b32 s28, s20, 1
    s_mul_i32 s28, s28, 81920
    s_and_b32 s29, s20, 1
    s_mul_i32 s29, s29, 25600
    s_add_u32 s28, s28, s29
    s_barrier
    s_add_u32 m0, s28, 0
    s_nop 0
    buffer_load_dwordx4 v4, s[40:43], s59 offen offset:0 sc1 lds
    s_add_u32 m0, s28, 768
    s_nop 0
    buffer_load_dwordx4 v4, s[40:43], s59 offen offset:256 sc1 lds
    s_add_u32 m0, s28, 1536
    s_nop 0
    buffer_load_dwordx4 v4, s[40:43], s59 offen offset:512 sc1 lds
    s_add_u32 m0, s28, 2304
    s_nop 0
    buffer_load_dwordx4 v4, s[40:43], s59 offen offset:768 sc1 lds
    s_add_u32 m0, s28, 3072
    s_nop 0
    buffer_load_dwordx4 v4, s[40:43], s59 offen offset:1024 sc1 lds
    s_add_u32 s59, s59, 40960
    s_add_u32 m0, s28, 5120
    s_nop 0
    buffer_load_dwordx4 v4, s[40:43], s59 offen offset:0 sc1 lds
    s_add_u32 m0, s28, 5888
    s_nop 0
    buffer_load_dwordx4 v4, s[40:43], s59 offen offset:256 sc1 lds
    s_add_u32 m0, s28, 6656
    s_nop 0
    buffer_load_dwordx4 v4, s[40:43], s59 offen offset:512 sc1 lds
    s_add_u32 m0, s28, 7424
    s_nop 0
    buffer_load_dwordx4 v4, s[40:43], s59 offen offset:768 sc1 lds
    s_add_u32 m0, s28, 8192
    s_nop 0
    buffer_load_dwordx4 v4, s[40:43], s59 offen offset:1024 sc1 lds
    s_add_u32 s59, s59, 40960
    s_add_u32 m0, s28, 10240
    s_nop 0
    buffer_load_dwordx4 v4, s[40:43], s59 offen offset:0 sc1 lds
    s_add_u32 m0, s28, 11008
    s_nop 0
    buffer_load_dwordx4 v4, s[40:43], s59 offen offset:256 sc1 lds
    s_add_u32 m0, s28, 11776
    s_nop 0
    buffer_load_dwordx4 v4, s[40:43], s59 offen offset:512 sc1 lds
    s_add_u32 m0, s28, 12544
    s_nop 0
    buffer_load_dwordx4 v4, s[40:43], s59 offen offset:768 sc1 lds
    s_add_u32 m0, s28, 13312
    s_nop 0
    buffer_load_dwordx4 v4, s[40:43], s59 offen offset:1024 sc1 lds
    s_add_u32 s59, s59, 40960
    s_add_u32 m0, s28, 15360
    s_nop 0
    buffer_load_dwordx4 v4, s[40:43], s59 offen offset:0 sc1 lds
    s_add_u32 m0, s28, 16128
    s_nop 0
    buffer_load_dwordx4 v4, s[40:43], s59 offen offset:256 sc1 lds
    s_add_u32 m0, s28, 16896
    s_nop 0
    buffer_load_dwordx4 v4, s[40:43], s59 offen offset:512 sc1 lds
    s_add_u32 m0, s28, 17664
    s_nop 0
    buffer_load_dwordx4 v4, s[40:43], s59 offen offset:768 sc1 lds
    s_add_u32 m0, s28, 18432
    s_nop 0
    buffer_load_dwordx4 v4, s[40:43], s59 offen offset:1024 sc1 lds
    s_add_u32 s59, s59, 40960
    s_add_u32 m0, s28, 20480
    s_nop 0
    buffer_load_dwordx4 v4, s[40:43], s59 offen offset:0 sc1 lds
    s_add_u32 m0, s28, 21248
    s_nop 0
    buffer_load_dwordx4 v4, s[40:43], s59 offen offset:256 sc1 lds
    s_add_u32 m0, s28, 22016
    s_nop 0
    buffer_load_dwordx4 v4, s[40:43], s59 offen offset:512 sc1 lds
    s_add_u32 m0, s28, 22784
    s_nop 0
    buffer_load_dwordx4 v4, s[40:43], s59 offen offset:768 sc1 lds
    s_add_u32 m0, s28, 23552
    s_nop 0
    buffer_load_dwordx4 v4, s[40:43], s59 offen offset:1024 sc1 lds
    s_add_u32 s59, s59, 40960
    s_lshl_b32 s30, s20, 8
    v_add_u32 v3, s30, v3
    v_and_b32 v13, 0x7fff, v3
    v_lshrrev_b32 v13, 1, v13
    v_and_b32 v12, 0xffff8000, v3
    v_add_u32 v13, v13, v12
    v_add_u32 v12, 16384, v13
    v_add_u32 v8, 81920, v2
    v_mov_b32 v7, 1
    s_lshr_b32 s30, s2, 5
    s_lshl_b32 s30, s30, 5
    s_add_u32 s30, s30, s21
    s_lshl_b32 s30, s30, 2
    s_lshr_b32 s31, s56, 2
    s_lshl_b32 s31, s31, 7
    v_lshlrev_b32 v10, 2, v1
    v_add_u32 v10, s31, v10
    s_cmp_lg_u32 s20, 0
    s_cbranch_scc1 K2_KP0
    v_mov_b32 v16, v88
    v_mov_b32 v17, v89
    v_mov_b32 v18, v90
    v_mov_b32 v19, v91
    v_mov_b32 v20, v92
    v_mov_b32 v21, v93
    v_mov_b32 v22, v94
    v_mov_b32 v23, v95
    v_mov_b32 v24, v96
    v_mov_b32 v25, v97
    v_mov_b32 v26, v98
    v_mov_b32 v27, v99
    v_mov_b32 v28, v100
    v_mov_b32 v29, v101
    v_mov_b32 v30, v102
    v_mov_b32 v31, v103
    v_mov_b32 v32, v104
    v_mov_b32 v33, v105
    v_mov_b32 v34, v106
    v_mov_b32 v35, v107
K2_KP0:
    s_cmp_lg_u32 s20, 1
    s_cbranch_scc1 K2_KP1
    v_mov_b32 v16, v108
    v_mov_b32 v17, v109
    v_mov_b32 v18, v110
    v_mov_b32 v19, v111
    v_mov_b32 v20, v112
    v_mov_b32 v21, v113
    v_mov_b32 v22, v114
    v_mov_b32 v23, v115
    v_mov_b32 v24, v116
    v_mov_b32 v25, v117
    v_mov_b32 v26, v118
    v_mov_b32 v27, v119
    v_mov_b32 v28, v120
    v_mov_b32 v29, v121
    v_mov_b32 v30, v122
    v_mov_b32 v31, v123
    v_mov_b32 v32, v124
    v_mov_b32 v33, v125
    v_mov_b32 v34, v126
    v_mov_b32 v35, v127
K2_KP1:
    s_cmp_lg_u32 s20, 2
    s_cbranch_scc1 K2_KP2
    v_mov_b32 v16, v128
    v_mov_b32 v17, v129
    v_mov_b32 v18, v130
    v_mov_b32 v19, v131
    v_mov_b32 v20, v132
    v_mov_b32 v21, v133
    v_mov_b32 v22, v134
    v_mov_b32 v23, v135
    v_mov_b32 v24, v136
    v_mov_b32 v25, v137
    v_mov_b32 v26, v138
    v_mov_b32 v27, v139
    v_mov_b32 v28, v140
    v_mov_b32 v29, v141
    v_mov_b32 v30, v142
    v_mov_b32 v31, v143
    v_mov_b32 v32, v144
    v_mov_b32 v33, v145
    v_mov_b32 v34, v146
    v_mov_b32 v35, v147
K2_KP2:
    s_cmp_lg_u32 s20, 3
    s_cbranch_scc1 K2_KP3
    v_mov_b32 v16, v148
    v_mov_b32 v17, v149
    v_mov_b32 v18, v150
    v_mov_b32 v19, v151
    v_mov_b32 v20, v152
    v_mov_b32 v21, v153
    v_mov_b32 v22, v154
    v_mov_b32 v23, v155
    v_mov_b32 v24, v156
    v_mov_b32 v25, v157
    v_mov_b32 v26, v158
    v_mov_b32 v27, v159
    v_mov_b32 v28, v160
    v_mov_b32 v29, v161
    v_mov_b32 v30, v162
    v_mov_b32 v31, v163
    v_mov_b32 v32, v164
    v_mov_b32 v33, v165
    v_mov_b32 v34, v166
    v_mov_b32 v35, v167
K2_KP3:
    s_waitcnt vmcnt(25)
    v_lshlrev_b32 v36, 16, v68
    v_and_b32 v37, 0xffff0000, v68
    v_lshlrev_b32 v38, 16, v69
    v_and_b32 v39, 0xffff0000, v69
    v_lshlrev_b32 v40, 16, v78
    v_and_b32 v41, 0xffff0000, v78
    v_lshlrev_b32 v42, 16, v79
    v_and_b32 v43, 0xffff0000, v79
    v_add_f32 v16, v16, v36
    v_add_f32 v17, v17, v37
    v_add_f32 v18, v18, v38
    v_add_f32 v19, v19, v39
    v_add_f32 v16, v16, v40
    v_add_f32 v17, v17, v41
    v_add_f32 v18, v18, v42
    v_add_f32 v19, v19, v43
    v_lshlrev_b32 v36, 16, v70
    v_and_b32 v37, 0xffff0000, v70
    v_lshlrev_b32 v38, 16, v71
    v_and_b32 v39, 0xffff0000, v71
    v_lshlrev_b32 v40, 16, v80
    v_and_b32 v41, 0xffff0000, v80
    v_lshlrev_b32 v42, 16, v81
    v_and_b32 v43, 0xffff0000, v81
    v_add_f32 v20, v20, v36
    v_add_f32 v21, v21, v37
    v_add_f32 v22, v22, v38
    v_add_f32 v23, v23, v39
    v_add_f32 v20, v20, v40
    v_add_f32 v21, v21, v41
    v_add_f32 v22, v22, v42
    v_add_f32 v23, v23, v43
    v_lshlrev_b32 v36, 16, v72
    v_and_b32 v37, 0xffff0000, v72
    v_lshlrev_b32 v38, 16, v73
    v_and_b32 v39, 0xffff0000, v73
    v_lshlrev_b32 v40, 16, v82
    v_and_b32 v41, 0xffff0000, v82
    v_lshlrev_b32 v42, 16, v83
    v_and_b32 v43, 0xffff0000, v83
    v_add_f32 v24, v24, v36
    v_add_f32 v25, v25, v37
    v_add_f32 v26, v26, v38
    v_add_f32 v27, v27, v39
    v_add_f32 v24, v24, v40
    v_add_f32 v25, v25, v41
    v_add_f32 v26, v26, v42
    v_add_f32 v27, v27, v43
    v_lshlrev_b32 v36, 16, v74
    v_and_b32 v37, 0xffff0000, v74
    v_lshlrev_b32 v38, 16, v75
    v_and_b32 v39, 0xffff0000, v75
    v_lshlrev_b32 v40, 16, v84
    v_and_b32 v41, 0xffff0000, v84
    v_lshlrev_b32 v42, 16, v85
    v_and_b32 v43, 0xffff0000, v85
    v_add_f32 v28, v28, v36
    v_add_f32 v29, v29, v37
    v_add_f32 v30, v30, v38
    v_add_f32 v31, v31, v39
    v_add_f32 v28, v28, v40
    v_add_f32 v29, v29, v41
    v_add_f32 v30, v30, v42
    v_add_f32 v31, v31, v43
    v_lshlrev_b32 v36, 16, v76
    v_and_b32 v37, 0xffff0000, v76
    v_lshlrev_b32 v38, 16, v77
    v_and_b32 v39, 0xffff0000, v77
    v_lshlrev_b32 v40, 16, v86
    v_and_b32 v41, 0xffff0000, v86
    v_lshlrev_b32 v42, 16, v87
    v_and_b32 v43, 0xffff0000, v87
    v_add_f32 v32, v32, v36
    v_add_f32 v33, v33, v37
    v_add_f32 v34, v34, v38
    v_add_f32 v35, v35, v39
    v_add_f32 v32, v32, v40
    v_add_f32 v33, v33, v41
    v_add_f32 v34, v34, v42
    v_add_f32 v35, v35, v43
    s_barrier
    s_waitcnt vmcnt(0)
    s_barrier
    s_cmp_lg_u32 s20, 0
    s_cbranch_scc1 K2_NF
    s_mov_b64 exec, 1
    buffer_store_dword v7, v6, s[64:67], s30 offen sc1
    s_mov_b64 exec, -1
K2_NF:
    s_cmp_eq_u32 s20, 0
    s_cbranch_scc1 K2_SK0
    s_cmp_gt_u32 s20, 0
    s_cselect_b32 s29, -1, 0
    s_add_u32 s29, s29, s20
    s_mul_i32 s28, s29, 5120
    s_cmp_ge_u32 s29, 6
    s_mov_b32 s29, 51200
    s_cselect_b32 s29, 102400, s29
    s_add_u32 s28, s28, s29
    v_add_u32 v9, s28, v2
    ds_write_b128 v9, v[88:91] offset:0
    ds_write_b128 v9, v[92:95] offset:1024
    ds_write_b128 v9, v[96:99] offset:2048
    ds_write_b128 v9, v[100:103] offset:3072
    ds_write_b128 v9, v[104:107] offset:4096
K2_SK0:
    s_cmp_eq_u32 s20, 1
    s_cbranch_scc1 K2_SK1
    s_cmp_gt_u32 s20, 1
    s_cselect_b32 s29, 2, 3
    s_add_u32 s29, s29, s20
    s_mul_i32 s28, s29, 5120
    s_cmp_ge_u32 s29, 6
    s_mov_b32 s29, 51200
    s_cselect_b32 s29, 102400, s29
    s_add_u32 s28, s28, s29
    v_add_u32 v9, s28, v2
    ds_write_b128 v9, v[108:111] offset:0
    ds_write_b128 v9, v[112:115] offset:1024
    ds_write_b128 v9, v[116:119] offset:2048
    ds_write_b128 v9, v[120:123] offset:3072
    ds_write_b128 v9, v[124:127] offset:4096
K2_SK1:
    s_cmp_eq_u32 s20, 2
    s_cbranch_scc1 K2_SK2
    s_cmp_gt_u32 s20, 2
    s_cselect_b32 s29, 5, 6
    s_add_u32 s29, s29, s20
    s_mul_i32 s28, s29, 5120
    s_cmp_ge_u32 s29, 6
    s_mov_b32 s29, 51200
    s_cselect_b32 s29, 102400, s29
    s_add_u32 s28, s28, s29
    v_add_u32 v9, s28, v2
    ds_write_b128 v9, v[128:131] offset:0
    ds_write_b128 v9, v[132:135] offset:1024
    ds_write_b128 v9, v[136:139] offset:2048
    ds_write_b128 v9, v[140:143] offset:3072
    ds_write_b128 v9, v[144:147] offset:4096
K2_SK2:
    s_cmp_eq_u32 s20, 3
    s_cbranch_scc1 K2_SK3
    s_cmp_gt_u32 s20, 3
    s_cselect_b32 s29, 8, 9
    s_add_u32 s29, s29, s20
    s_mul_i32 s28, s29, 5120
    s_cmp_ge_u32 s29, 6
    s_mov_b32 s29, 51200
    s_cselect_b32 s29, 102400, s29
    s_add_u32 s28, s28, s29
    v_add_u32 v9, s28, v2
    ds_write_b128 v9, v[148:151] offset:0
    ds_write_b128 v9, v[152:155] offset:1024
    ds_write_b128 v9, v[156:159] offset:2048
    ds_write_b128 v9, v[160:163] offset:3072
    ds_write_b128 v9, v[164:167] offset:4096
K2_SK3:
    s_mul_i32 s29, s20, 3
    s_mul_i32 s28, s29, 5120
    s_cmp_ge_u32 s29, 6
    s_mov_b32 s29, 51200
    s_cselect_b32 s29, 102400, s29
    s_add_u32 s28, s28, s29
    v_add_u32 v9, s28, v2
    s_waitcnt lgkmcnt(0)
    s_barrier
    ds_read_b128 v[88:91], v9 offset:0
    ds_read_b128 v[92:95], v9 offset:1024
    ds_read_b128 v[96:99], v9 offset:2048
    ds_read_b128 v[100:103], v9 offset:3072
    ds_read_b128 v[104:107], v9 offset:4096
    ds_read_b128 v[108:111], v9 offset:5120
    ds_read_b128 v[112:115], v9 offset:6144
    ds_read_b128 v[116:119], v9 offset:7168
    ds_read_b128 v[120:123], v9 offset:8192
    ds_read_b128 v[124:127], v9 offset:9216
    ds_read_b128 v[128:131], v9 offset:10240
    ds_read_b128 v[132:135], v9 offset:11264
    ds_read_b128 v[136:139], v9 offset:12288
    ds_read_b128 v[140:143], v9 offset:13312
    ds_read_b128 v[144:147], v9 offset:14336
    s_waitcnt lgkmcnt(10)
    v_add_f32 v16, v16, v88
    v_add_f32 v17, v17, v89
    v_add_f32 v18, v18, v90
    v_add_f32 v19, v19, v91
    v_add_f32 v20, v20, v92
    v_add_f32 v21, v21, v93
    v_add_f32 v22, v22, v94
    v_add_f32 v23, v23, v95
    v_add_f32 v24, v24, v96
    v_add_f32 v25, v25, v97
    v_add_f32 v26, v26, v98
    v_add_f32 v27, v27, v99
    v_add_f32 v28, v28, v100
    v_add_f32 v29, v29, v101
    v_add_f32 v30, v30, v102
    v_add_f32 v31, v31, v103
    v_add_f32 v32, v32, v104
    v_add_f32 v33, v33, v105
    v_add_f32 v34, v34, v106
    v_add_f32 v35, v35, v107
    s_waitcnt lgkmcnt(5)
    v_add_f32 v16, v16, v108
    v_add_f32 v17, v17, v109
    v_add_f32 v18, v18, v110
    v_add_f32 v19, v19, v111
    v_add_f32 v20, v20, v112
    v_add_f32 v21, v21, v113
    v_add_f32 v22, v22, v114
    v_add_f32 v23, v23, v115
    v_add_f32 v24, v24, v116
    v_add_f32 v25, v25, v117
    v_add_f32 v26, v26, v118
    v_add_f32 v27, v27, v119
    v_add_f32 v28, v28, v120
    v_add_f32 v29, v29, v121
    v_add_f32 v30, v30, v122
    v_add_f32 v31, v31, v123
    v_add_f32 v32, v32, v124
    v_add_f32 v33, v33, v125
    v_add_f32 v34, v34, v126
    v_add_f32 v35, v35, v127
    s_waitcnt lgkmcnt(0)
    v_add_f32 v16, v16, v128
    v_add_f32 v17, v17, v129
    v_add_f32 v18, v18, v130
    v_add_f32 v19, v19, v131
    v_add_f32 v20, v20, v132
    v_add_f32 v21, v21, v133
    v_add_f32 v22, v22, v134
    v_add_f32 v23, v23, v135
    v_add_f32 v24, v24, v136
    v_add_f32 v25, v25, v137
    v_add_f32 v26, v26, v138
    v_add_f32 v27, v27, v139
    v_add_f32 v28, v28, v140
    v_add_f32 v29, v29, v141
    v_add_f32 v30, v30, v142
    v_add_f32 v31, v31, v143
    v_add_f32 v32, v32, v144
    v_add_f32 v33, v33, v145
    v_add_f32 v34, v34, v146
    v_add_f32 v35, v35, v147
    s_cmp_lg_u32 s20, 0
    s_cbranch_scc1 K2_PW
    s_mov_b32 exec_hi, 0
    s_mov_b32 s24, 0
GP_o:
    buffer_load_dword v9, v10, s[64:67], 0 offen sc1
    s_add_u32 s24, s24, 1
    s_waitcnt vmcnt(0)
    v_cmp_ne_u32 vcc, 1, v9
    s_cmp_ge_u32 s24, 2097152
    s_cbranch_scc1 GD_o
    s_cbranch_vccz GD_o
    s_sleep 3
    s_branch GP_o
GD_o:
    s_mov_b64 exec, -1
K2_PW:
    s_barrier
    s_mov_b32 s58, 0
    buffer_load_dwordx4 v[88:91], v3, s[36:39], s58 offen sc1
    s_add_u32 s58, s58, 131072
    buffer_load_dwordx4 v[92:95], v3, s[36:39], s58 offen sc1
    s_add_u32 s58, s58, 131072
    buffer_load_dwordx4 v[96:99], v3, s[36:39], s58 offen sc1
    s_add_u32 s58, s58, 131072
    buffer_load_dwordx4 v[100:103], v3, s[36:39], s58 offen sc1
    s_add_u32 s58, s58, 131072
    buffer_load_dwordx4 v[104:107], v3, s[36:39], s58 offen sc1
    s_add_u32 s58, s58, 131072
    buffer_load_dwordx4 v[108:111], v3, s[36:39], s58 offen sc1
    s_add_u32 s58, s58, 131072
    buffer_load_dwordx4 v[112:115], v3, s[36:39], s58 offen sc1
    s_add_u32 s58, s58, 131072
    buffer_load_dwordx4 v[116:119], v3, s[36:39], s58 offen sc1
    s_add_u32 s58, s58, 131072
    buffer_load_dwordx4 v[120:123], v3, s[36:39], s58 offen sc1
    s_add_u32 s58, s58, 131072
    buffer_load_dwordx4 v[124:127], v3, s[36:39], s58 offen sc1
    s_add_u32 s58, s58, 131072
    buffer_load_dwordx4 v[128:131], v3, s[36:39], s58 offen sc1
    s_add_u32 s58, s58, 131072
    buffer_load_dwordx4 v[132:135], v3, s[36:39], s58 offen sc1
    s_add_u32 s58, s58, 131072
    buffer_load_dwordx4 v[136:139], v3, s[36:39], s58 offen sc1
    s_add_u32 s58, s58, 131072
    buffer_load_dwordx4 v[140:143], v3, s[36:39], s58 offen sc1
    s_add_u32 s58, s58, 131072
    buffer_load_dwordx4 v[144:147], v3, s[36:39], s58 offen sc1
    s_add_u32 s58, s58, 131072
    buffer_load_dwordx4 v[148:151], v3, s[36:39], s58 offen sc1
    s_add_u32 s58, s58, 131072
    buffer_load_dwordx2 v[152:153], v13, s[36:39], s58 offen sc1
    buffer_load_dwordx2 v[154:155], v12, s[36:39], s58 offen sc1
    s_add_u32 s58, s58, 131072
    buffer_load_dwordx2 v[156:157], v13, s[36:39], s58 offen sc1
    buffer_load_dwordx2 v[158:159], v12, s[36:39], s58 offen sc1
    s_add_u32 s58, s58, 131072
    buffer_load_dwordx2 v[160:161], v13, s[36:39], s58 offen sc1
    buffer_load_dwordx2 v[162:163], v12, s[36:39], s58 offen sc1
    s_add_u32 s58, s58, 131072
    buffer_load_dwordx2 v[164:165], v13, s[36:39], s58 offen sc1
    buffer_load_dwordx2 v[166:167], v12, s[36:39], s58 offen sc1
    s_add_u32 s58, s58, 131072
    ds_read_b128 v[36:39], v2 offset:0
    ds_read_b128 v[40:43], v2 offset:1024
    ds_read_b128 v[44:47], v2 offset:2048
    ds_read_b128 v[48:51], v2 offset:3072
    ds_read_b128 v[52:55], v2 offset:4096
    ds_read_b128 v[56:59], v2 offset:5120
    ds_read_b128 v[60:63], v2 offset:6144
    ds_read_b128 v[64:67], v2 offset:7168
    ds_read_b128 v[68:71], v2 offset:8192
    ds_read_b128 v[72:75], v2 offset:9216
    s_waitcnt vmcnt(23) lgkmcnt(5)
    v_mfma_f32_16x16x32_bf16 v[16:19], v[36:39], v[88:91], v[16:19]
    v_mfma_f32_16x16x32_bf16 v[20:23], v[40:43], v[88:91], v[20:23]
    v_mfma_f32_16x16x32_bf16 v[24:27], v[44:47], v[88:91], v[24:27]
    v_mfma_f32_16x16x32_bf16 v[28:31], v[48:51], v[88:91], v[28:31]
    v_mfma_f32_16x16x32_bf16 v[32:35], v[52:55], v[88:91], v[32:35]
    ds_read_b128 v[36:39], v2 offset:10240
    ds_read_b128 v[40:43], v2 offset:11264
    ds_read_b128 v[44:47], v2 offset:12288
    ds_read_b128 v[48:51], v2 offset:13312
    ds_read_b128 v[52:55], v2 offset:14336
    s_waitcnt vmcnt(22) lgkmcnt(5)
    v_mfma_f32_16x16x32_bf16 v[16:19], v[56:59], v[92:95], v[16:19]
    v_mfma_f32_16x16x32_bf16 v[20:23], v[60:63], v[92:95], v[20:23]
    v_mfma_f32_16x16x32_bf16 v[24:27], v[64:67], v[92:95], v[24:27]
    v_mfma_f32_16x16x32_bf16 v[28:31], v[68:71], v[92:95], v[28:31]
    v_mfma_f32_16x16x32_bf16 v[32:35], v[72:75], v[92:95], v[32:35]
    ds_read_b128 v[56:59], v2 offset:15360
    ds_read_b128 v[60:63], v2 offset:16384
    ds_read_b128 v[64:67], v2 offset:17408
    ds_read_b128 v[68:71], v2 offset:18432
    ds_read_b128 v[72:75], v2 offset:19456
    s_waitcnt vmcnt(21) lgkmcnt(5)
    v_mfma_f32_16x16x32_bf16 v[16:19], v[36:39], v[96:99], v[16:19]
    v_mfma_f32_16x16x32_bf16 v[20:23], v[40:43], v[96:99], v[20:23]
    v_mfma_f32_16x16x32_bf16 v[24:27], v[44:47], v[96:99], v[24:27]
    v_mfma_f32_16x16x32_bf16 v[28:31], v[48:51], v[96:99], v[28:31]
    v_mfma_f32_16x16x32_bf16 v[32:35], v[52:55], v[96:99], v[32:35]
    ds_read_b128 v[36:39], v2 offset:20480
    ds_read_b128 v[40:43], v2 offset:21504
    ds_read_b128 v[44:47], v2 offset:22528
    ds_read_b128 v[48:51], v2 offset:23552
    ds_read_b128 v[52:55], v2 offset:24576
    s_waitcnt vmcnt(20) lgkmcnt(5)
    v_mfma_f32_16x16x32_bf16 v[16:19], v[56:59], v[100:103], v[16:19]
    v_mfma_f32_16x16x32_bf16 v[20:23], v[60:63], v[100:103], v[20:23]
    v_mfma_f32_16x16x32_bf16 v[24:27], v[64:67], v[100:103], v[24:27]
    v_mfma_f32_16x16x32_bf16 v[28:31], v[68:71], v[100:103], v[28:31]
    v_mfma_f32_16x16x32_bf16 v[32:35], v[72:75], v[100:103], v[32:35]
    ds_read_b128 v[56:59], v2 offset:25600
    ds_read_b128 v[60:63], v2 offset:26624
    ds_read_b128 v[64:67], v2 offset:27648
    ds_read_b128 v[68:71], v2 offset:28672
    ds_read_b128 v[72:75], v2 offset:29696
    s_waitcnt vmcnt(19) lgkmcnt(5)
    v_mfma_f32_16x16x32_bf16 v[16:19], v[36:39], v[104:107], v[16:19]
    v_mfma_f32_16x16x32_bf16 v[20:23], v[40:43], v[104:107], v[20:23]
    v_mfma_f32_16x16x32_bf16 v[24:27], v[44:47], v[104:107], v[24:27]
    v_mfma_f32_16x16x32_bf16 v[28:31], v[48:51], v[104:107], v[28:31]
    v_mfma_f32_16x16x32_bf16 v[32:35], v[52:55], v[104:107], v[32:35]
    ds_read_b128 v[36:39], v2 offset:30720
    ds_read_b128 v[40:43], v2 offset:31744
    ds_read_b128 v[44:47], v2 offset:32768
    ds_read_b128 v[48:51], v2 offset:33792
    ds_read_b128 v[52:55], v2 offset:34816
    s_waitcnt vmcnt(18) lgkmcnt(5)
    v_mfma_f32_16x16x32_bf16 v[16:19], v[56:59], v[108:111], v[16:19]
    v_mfma_f32_16x16x32_bf16 v[20:23], v[60:63], v[108:111], v[20:23]
    v_mfma_f32_16x16x32_bf16 v[24:27], v[64:67], v[108:111], v[24:27]
    v_mfma_f32_16x16x32_bf16 v[28:31], v[68:71], v[108:111], v[28:31]
    v_mfma_f32_16x16x32_bf16 v[32:35], v[72:75], v[108:111], v[32:35]
    ds_read_b128 v[56:59], v2 offset:35840
    ds_read_b128 v[60:63], v2 offset:36864
    ds_read_b128 v[64:67], v2 offset:37888
    ds_read_b128 v[68:71], v2 offset:38912
    ds_read_b128 v[72:75], v2 offset:39936
    s_waitcnt vmcnt(17) lgkmcnt(5)
    v_mfma_f32_16x16x32_bf16 v[16:19], v[36:39], v[112:115], v[16:19]
    v_mfma_f32_16x16x32_bf16 v[20:23], v[40:43], v[112:115], v[20:23]
    v_mfma_f32_16x16x32_bf16 v[24:27], v[44:47], v[112:115], v[24:27]
    v_mfma_f32_16x16x32_bf16 v[28:31], v[48:51], v[112:115], v[28:31]
    v_mfma_f32_16x16x32_bf16 v[32:35], v[52:55], v[112:115], v[32:35]
    ds_read_b128 v[36:39], v2 offset:40960
    ds_read_b128 v[40:43], v2 offset:41984
    ds_read_b128 v[44:47], v2 offset:43008
    ds_read_b128 v[48:51], v2 offset:44032
    ds_read_b128 v[52:55], v2 offset:45056
    s_waitcnt vmcnt(16) lgkmcnt(5)
    v_mfma_f32_16x16x32_bf16 v[16:19], v[56:59], v[116:119], v[16:19]
    v_mfma_f32_16x16x32_bf16 v[20:23], v[60:63], v[116:119], v[20:23]
    v_mfma_f32_16x16x32_bf16 v[24:27], v[64:67], v[116:119], v[24:27]
    v_mfma_f32_16x16x32_bf16 v[28:31], v[68:71], v[116:119], v[28:31]
    v_mfma_f32_16x16x32_bf16 v[32:35], v[72:75], v[116:119], v[32:35]
    ds_read_b128 v[56:59], v2 offset:46080
    ds_read_b128 v[60:63], v2 offset:47104
    ds_read_b128 v[64:67], v2 offset:48128
    ds_read_b128 v[68:71], v2 offset:49152
    ds_read_b128 v[72:75], v2 offset:50176
    s_waitcnt vmcnt(15) lgkmcnt(5)
    v_mfma_f32_16x16x32_bf16 v[16:19], v[36:39], v[120:123], v[16:19]
    v_mfma_f32_16x16x32_bf16 v[20:23], v[40:43], v[120:123], v[20:23]
    v_mfma_f32_16x16x32_bf16 v[24:27], v[44:47], v[120:123], v[24:27]
    v_mfma_f32_16x16x32_bf16 v[28:31], v[48:51], v[120:123], v[28:31]
    v_mfma_f32_16x16x32_bf16 v[32:35], v[52:55], v[120:123], v[32:35]
    ds_read_b128 v[36:39], v8 offset:0
    ds_read_b128 v[40:43], v8 offset:1024
    ds_read_b128 v[44:47], v8 offset:2048
    ds_read_b128 v[48:51], v8 offset:3072
    ds_read_b128 v[52:55], v8 offset:4096
    s_waitcnt vmcnt(14) lgkmcnt(5)
    v_mfma_f32_16x16x32_bf16 v[16:19], v[56:59], v[124:127], v[16:19]
    v_mfma_f32_16x16x32_bf16 v[20:23], v[60:63], v[124:127], v[20:23]
    v_mfma_f32_16x16x32_bf16 v[24:27], v[64:67], v[124:127], v[24:27]
    v_mfma_f32_16x16x32_bf16 v[28:31], v[68:71], v[124:127], v[28:31]
    v_mfma_f32_16x16x32_bf16 v[32:35], v[72:75], v[124:127], v[32:35]
    ds_read_b128 v[56:59], v8 offset:5120
    ds_read_b128 v[60:63], v8 offset:6144
    ds_read_b128 v[64:67], v8 offset:7168
    ds_read_b128 v[68:71], v8 offset:8192
    ds_read_b128 v[72:75], v8 offset:9216
    s_waitcnt vmcnt(13) lgkmcnt(5)
    v_mfma_f32_16x16x32_bf16 v[16:19], v[36:39], v[128:131], v[16:19]
    v_mfma_f32_16x16x32_bf16 v[20:23], v[40:43], v[128:131], v[20:23]
    v_mfma_f32_16x16x32_bf16 v[24:27], v[44:47], v[128:131], v[24:27]
    v_mfma_f32_16x16x32_bf16 v[28:31], v[48:51], v[128:131], v[28:31]
    v_mfma_f32_16x16x32_bf16 v[32:35], v[52:55], v[128:131], v[32:35]
    ds_read_b128 v[36:39], v8 offset:10240
    ds_read_b128 v[40:43], v8 offset:11264
    ds_read_b128 v[44:47], v8 offset:12288
    ds_read_b128 v[48:51], v8 offset:13312
    ds_read_b128 v[52:55], v8 offset:14336
    s_waitcnt vmcnt(12) lgkmcnt(5)
    v_mfma_f32_16x16x32_bf16 v[16:19], v[56:59], v[132:135], v[16:19]
    v_mfma_f32_16x16x32_bf16 v[20:23], v[60:63], v[132:135], v[20:23]
    v_mfma_f32_16x16x32_bf16 v[24:27], v[64:67], v[132:135], v[24:27]
    v_mfma_f32_16x16x32_bf16 v[28:31], v[68:71], v[132:135], v[28:31]
    v_mfma_f32_16x16x32_bf16 v[32:35], v[72:75], v[132:135], v[32:35]
    ds_read_b128 v[56:59], v8 offset:15360
    ds_read_b128 v[60:63], v8 offset:16384
    ds_read_b128 v[64:67], v8 offset:17408
    ds_read_b128 v[68:71], v8 offset:18432
    ds_read_b128 v[72:75], v8 offset:19456
    s_waitcnt vmcnt(11) lgkmcnt(5)
    v_mfma_f32_16x16x32_bf16 v[16:19], v[36:39], v[136:139], v[16:19]
    v_mfma_f32_16x16x32_bf16 v[20:23], v[40:43], v[136:139], v[20:23]
    v_mfma_f32_16x16x32_bf16 v[24:27], v[44:47], v[136:139], v[24:27]
    v_mfma_f32_16x16x32_bf16 v[28:31], v[48:51], v[136:139], v[28:31]
    v_mfma_f32_16x16x32_bf16 v[32:35], v[52:55], v[136:139], v[32:35]
    ds_read_b128 v[36:39], v8 offset:20480
    ds_read_b128 v[40:43], v8 offset:21504
    ds_read_b128 v[44:47], v8 offset:22528
    ds_read_b128 v[48:51], v8 offset:23552
    ds_read_b128 v[52:55], v8 offset:24576
    s_waitcnt vmcnt(10) lgkmcnt(5)
    v_mfma_f32_16x16x32_bf16 v[16:19], v[56:59], v[140:143], v[16:19]
    v_mfma_f32_16x16x32_bf16 v[20:23], v[60:63], v[140:143], v[20:23]
    v_mfma_f32_16x16x32_bf16 v[24:27], v[64:67], v[140:143], v[24:27]
    v_mfma_f32_16x16x32_bf16 v[28:31], v[68:71], v[140:143], v[28:31]
    v_mfma_f32_16x16x32_bf16 v[32:35], v[72:75], v[140:143], v[32:35]
    ds_read_b128 v[56:59], v8 offset:25600
    ds_read_b128 v[60:63], v8 offset:26624
    ds_read_b128 v[64:67], v8 offset:27648
    ds_read_b128 v[68:71], v8 offset:28672
    ds_read_b128 v[72:75], v8 offset:29696
    s_waitcnt vmcnt(9) lgkmcnt(5)
    v_mfma_f32_16x16x32_bf16 v[16:19], v[36:39], v[144:147], v[16:19]
    v_mfma_f32_16x16x32_bf16 v[20:23], v[40:43], v[144:147], v[20:23]
    v_mfma_f32_16x16x32_bf16 v[24:27], v[44:47], v[144:147], v[24:27]
    v_mfma_f32_16x16x32_bf16 v[28:31], v[48:51], v[144:147], v[28:31]
    v_mfma_f32_16x16x32_bf16 v[32:35], v[52:55], v[144:147], v[32:35]
    ds_read_b128 v[36:39], v8 offset:30720
    ds_read_b128 v[40:43], v8 offset:31744
    ds_read_b128 v[44:47], v8 offset:32768
    ds_read_b128 v[48:51], v8 offset:33792
    ds_read_b128 v[52:55], v8 offset:34816
    s_waitcnt vmcnt(8) lgkmcnt(5)
    v_mfma_f32_16x16x32_bf16 v[16:19], v[56:59], v[148:151], v[16:19]
    v_mfma_f32_16x16x32_bf16 v[20:23], v[60:63], v[148:151], v[20:23]
    v_mfma_f32_16x16x32_bf16 v[24:27], v[64:67], v[148:151], v[24:27]
    v_mfma_f32_16x16x32_bf16 v[28:31], v[68:71], v[148:151], v[28:31]
    v_mfma_f32_16x16x32_bf16 v[32:35], v[72:75], v[148:151], v[32:35]
    ds_read_b128 v[56:59], v8 offset:35840
    ds_read_b128 v[60:63], v8 offset:36864
    ds_read_b128 v[64:67], v8 offset:37888
    ds_read_b128 v[68:71], v8 offset:38912
    ds_read_b128 v[72:75], v8 offset:39936
    s_waitcnt vmcnt(6) lgkmcnt(5)
    v_mfma_f32_16x16x32_bf16 v[16:19], v[36:39], v[152:155], v[16:19]
    v_mfma_f32_16x16x32_bf16 v[20:23], v[40:43], v[152:155], v[20:23]
    v_mfma_f32_16x16x32_bf16 v[24:27], v[44:47], v[152:155], v[24:27]
    v_mfma_f32_16x16x32_bf16 v[28:31], v[48:51], v[152:155], v[28:31]
    v_mfma_f32_16x16x32_bf16 v[32:35], v[52:55], v[152:155], v[32:35]
    ds_read_b128 v[36:39], v8 offset:40960
    ds_read_b128 v[40:43], v8 offset:41984
    ds_read_b128 v[44:47], v8 offset:43008
    ds_read_b128 v[48:51], v8 offset:44032
    ds_read_b128 v[52:55], v8 offset:45056
    s_waitcnt vmcnt(4) lgkmcnt(5)
    v_mfma_f32_16x16x32_bf16 v[16:19], v[56:59], v[156:159], v[16:19]
    v_mfma_f32_16x16x32_bf16 v[20:23], v[60:63], v[156:159], v[20:23]
    v_mfma_f32_16x16x32_bf16 v[24:27], v[64:67], v[156:159], v[24:27]
    v_mfma_f32_16x16x32_bf16 v[28:31], v[68:71], v[156:159], v[28:31]
    v_mfma_f32_16x16x32_bf16 v[32:35], v[72:75], v[156:159], v[32:35]
    ds_read_b128 v[56:59], v8 offset:46080
    ds_read_b128 v[60:63], v8 offset:47104
    ds_read_b128 v[64:67], v8 offset:48128
    ds_read_b128 v[68:71], v8 offset:49152
    ds_read_b128 v[72:75], v8 offset:50176
    s_waitcnt vmcnt(2) lgkmcnt(5)
    v_mfma_f32_16x16x32_bf16 v[16:19], v[36:39], v[160:163], v[16:19]
    v_mfma_f32_16x16x32_bf16 v[20:23], v[40:43], v[160:163], v[20:23]
    v_mfma_f32_16x16x32_bf16 v[24:27], v[44:47], v[160:163], v[24:27]
    v_mfma_f32_16x16x32_bf16 v[28:31], v[48:51], v[160:163], v[28:31]
    v_mfma_f32_16x16x32_bf16 v[32:35], v[52:55], v[160:163], v[32:35]
    s_waitcnt vmcnt(0) lgkmcnt(0)
    v_mfma_f32_16x16x32_bf16 v[16:19], v[56:59], v[164:167], v[16:19]
    v_mfma_f32_16x16x32_bf16 v[20:23], v[60:63], v[164:167], v[20:23]
    v_mfma_f32_16x16x32_bf16 v[24:27], v[64:67], v[164:167], v[24:27]
    v_mfma_f32_16x16x32_bf16 v[28:31], v[68:71], v[164:167], v[28:31]
    v_mfma_f32_16x16x32_bf16 v[32:35], v[72:75], v[164:167], v[32:35]
    s_nop 7
    v_cvt_pk_bf16_f32 v16, v16, v17
    v_cvt_pk_bf16_f32 v17, v18, v19
    buffer_store_dwordx2 v[16:17], v5, s[52:55], 0 offen offset:0
    v_cvt_pk_bf16_f32 v20, v20, v21
    v_cvt_pk_bf16_f32 v21, v22, v23
    buffer_store_dwordx2 v[20:21], v5, s[52:55], 0 offen offset:32
    v_cvt_pk_bf16_f32 v24, v24, v25
    v_cvt_pk_bf16_f32 v25, v26, v27
    buffer_store_dwordx2 v[24:25], v5, s[52:55], 0 offen offset:64
    v_cvt_pk_bf16_f32 v28, v28, v29
    v_cvt_pk_bf16_f32 v29, v30, v31
    buffer_store_dwordx2 v[28:29], v5, s[52:55], 0 offen offset:96
    v_cvt_pk_bf16_f32 v32, v32, v33
    v_cvt_pk_bf16_f32 v33, v34, v35
    buffer_store_dwordx2 v[32:33], v5, s[52:55], 0 offen offset:128
    s_endpgm
K2_ATT:
    s_mov_b32 s12, s4
    s_mov_b32 s13, s5
    s_mov_b32 s14, 0x013cb000
    s_mov_b32 s15, 0x00020000
    s_lshr_b32 s25, s20, 3
    s_lshr_b32 s29, s29, 2
    s_lshl_b32 s29, s29, 3
    s_and_b32 s30, s20, 3
    s_lshl_b32 s30, s30, 1
    s_add_u32 s22, s29, s30
    s_mul_i32 s28, s21, 81920
    s_mul_i32 s29, s22, 1280
    s_add_u32 s28, s28, s29
    v_and_b32 v6, 31, v1
    v_lshrrev_b32 v7, 5, v1
    v_lshlrev_b32 v53, 3, v6
    v_lshl_add_u32 v8, v7, 30, v53
    v_add_u32 v53, 1024, v53
    v_lshlrev_b32 v52, 3, v1
    v_min_u32 v9, 20, v6
    v_bfe_u32 v10, v9, 1, 3
    v_xor_b32 v10, v10, v7
    v_lshlrev_b32 v10, 4, v10
    v_lshl_add_u32 v54, v9, 7, v10
    v_cmp_lt_u32 vcc, 20, v6
    v_cmp_ne_u32 s[30:31], 24, v6
    v_mov_b32 v10, 0x01000000
    s_nop 0
    s_and_b64 vcc, vcc, s[30:31]
    v_cndmask_b32 v54, v54, v10, vcc
    v_lshl_add_u32 v53, v7, 24, v53
    v_xor_b32 v18, 32, v54
    v_xor_b32 v19, 64, v54
    v_xor_b32 v26, 96, v54
    s_mul_i32 s23, s25, 83968
    s_add_u32 s23, s23, 78720
    s_add_u32 s29, s23, 3968
    buffer_load_dwordx2 v[12:13], v52, s[12:15], s28 offen sc1
    buffer_load_dwordx2 v[14:15], v52, s[12:15], s28 offen offset:512 sc1
    buffer_load_dwordx2 v[16:17], v8, s[12:15], s28 offen offset:1024 sc1
    buffer_load_dwordx2 v[28:29], v52, s[16:19], s23 offen sc1
    buffer_load_dwordx2 v[30:31], v52, s[16:19], s23 offen offset:512 sc1
    buffer_load_dwordx2 v[32:33], v53, s[16:19], s23 offen sc1
    buffer_load_dwordx2 v[20:21], v52, s[12:15], s28 offen offset:1280 sc1
    buffer_load_dwordx2 v[22:23], v52, s[12:15], s28 offen offset:1792 sc1
    buffer_load_dwordx2 v[24:25], v8, s[12:15], s28 offen offset:2304 sc1
    buffer_load_dwordx2 v[56:57], v52, s[16:19], s29 offen sc1
    buffer_load_dwordx2 v[58:59], v52, s[16:19], s29 offen offset:512 sc1
    buffer_load_dwordx2 v[130:131], v53, s[16:19], s29 offen sc1
    s_mul_i32 s29, s25, 81920
    v_add_u32 v3, s29, v52
    v_add_u32 v4, s29, v53
    v_add_u32 v5, s29, v54
    v_add_u32 v18, s29, v18
    v_add_u32 v19, s29, v19
    v_add_u32 v26, s29, v26
    v_add_u32 v6, 78720, v5
    v_add_u32 v7, 78720, v18
    v_add_u32 v8, 78720, v19
    v_add_u32 v9, 78720, v26
    v_mov_b32 v64, 0
    v_mov_b32 v65, 0
    v_mov_b32 v66, 0
    v_mov_b32 v67, 0
    v_mov_b32 v68, 0
    v_mov_b32 v69, 0
    v_mov_b32 v70, 0
    v_mov_b32 v71, 0
    v_mov_b32 v72, 0
    v_mov_b32 v73, 0
    v_mov_b32 v74, 0
    v_mov_b32 v75, 0
    v_mov_b32 v76, 0
    v_mov_b32 v77, 0
    v_mov_b32 v78, 0
    v_mov_b32 v79, 0
    v_mov_b32 v80, 0
    v_mov_b32 v81, 0
    v_mov_b32 v82, 0
    v_mov_b32 v83, 0
    v_mov_b32 v84, 0
    v_mov_b32 v85, 0
    v_mov_b32 v86, 0
    v_mov_b32 v87, 0
    v_mov_b32 v88, 0
    v_mov_b32 v89, 0
    v_mov_b32 v90, 0
    v_mov_b32 v91, 0
    v_mov_b32 v92, 0
    v_mov_b32 v93, 0
    v_mov_b32 v94, 0
    v_mov_b32 v95, 0
    s_mov_b32 s24, 0
    s_mov_b32 s32, 0x00000206
    s_waitcnt vmcnt(6)
    v_mfma_f32_32x32x16_bf16 v[96:111], v[28:31], v[12:15], 0
    v_mfma_f32_32x32x8_bf16 v[96:111], v[32:33], v[16:17], v[96:111]
    s_waitcnt vmcnt(0)
    s_nop 7
    s_setprio 2
    v_mfma_f32_32x32x16_bf16 v[112:127], v[28:31], v[20:23], 0
    v_mov_b32 v28, v56
    v_mov_b32 v29, v57
    v_mov_b32 v30, v58
    v_mov_b32 v31, v59
    v_exp_f32 v96, v96
    v_exp_f32 v97, v97
    v_exp_f32 v98, v98
    v_exp_f32 v99, v99
    v_cvt_pk_bf16_f32 v44, v96, v97
    v_cvt_pk_bf16_f32 v45, v98, v99
    v_mfma_f32_32x32x8_bf16 v[112:127], v[32:33], v[24:25], v[112:127]
    v_mov_b32 v32, v130
    v_mov_b32 v33, v131
    v_exp_f32 v104, v104
    v_exp_f32 v105, v105
    v_exp_f32 v106, v106
    v_exp_f32 v107, v107
    v_cvt_pk_bf16_f32 v46, v104, v105
    v_cvt_pk_bf16_f32 v47, v106, v107
    s_barrier
    ds_read_b128 v[36:39], v6
    ds_read_b128 v[40:43], v7
    ds_read_b128 v[60:63], v8
    ds_read_b128 v[132:135], v9
    v_exp_f32 v100, v100
    v_exp_f32 v101, v101
    v_exp_f32 v102, v102
    v_exp_f32 v103, v103
    v_cvt_pk_bf16_f32 v48, v100, v101
    v_cvt_pk_bf16_f32 v49, v102, v103
    s_waitcnt lgkmcnt(0)
    v_mfma_f32_32x32x16_bf16 v[64:79], v[36:39], v[44:47], v[64:79]
    v_exp_f32 v108, v108
    v_exp_f32 v109, v109
    v_exp_f32 v110, v110
    v_exp_f32 v111, v111
    v_cvt_pk_bf16_f32 v50, v108, v109
    v_cvt_pk_bf16_f32 v51, v110, v111
    v_mfma_f32_32x32x16_bf16 v[96:111], v[28:31], v[12:15], 0
    v_exp_f32 v112, v112
    v_exp_f32 v113, v113
    v_exp_f32 v114, v114
    v_exp_f32 v115, v115
    v_cvt_pk_bf16_f32 v44, v112, v113
    v_cvt_pk_bf16_f32 v45, v114, v115
    v_mfma_f32_32x32x8_bf16 v[96:111], v[32:33], v[16:17], v[96:111]
    v_exp_f32 v120, v120
    v_exp_f32 v121, v121
    v_exp_f32 v122, v122
    v_exp_f32 v123, v123
    v_cvt_pk_bf16_f32 v46, v120, v121
    v_cvt_pk_bf16_f32 v47, v122, v123
    v_mfma_f32_32x32x16_bf16 v[64:79], v[40:43], v[48:51], v[64:79]
    v_exp_f32 v116, v116
    v_exp_f32 v117, v117
    v_exp_f32 v118, v118
    v_exp_f32 v119, v119
    v_cvt_pk_bf16_f32 v48, v116, v117
    v_cvt_pk_bf16_f32 v49, v118, v119
    v_mfma_f32_32x32x16_bf16 v[80:95], v[36:39], v[44:47], v[80:95]
    v_mov_b32 v36, v60
    v_mov_b32 v37, v61
    v_mov_b32 v38, v62
    v_mov_b32 v39, v63
    v_exp_f32 v124, v124
    v_exp_f32 v125, v125
    v_exp_f32 v126, v126
    v_exp_f32 v127, v127
    v_cvt_pk_bf16_f32 v50, v124, v125
    v_cvt_pk_bf16_f32 v51, v126, v127
    s_barrier
    v_mfma_f32_32x32x16_bf16 v[112:127], v[28:31], v[20:23], 0
    ds_read_b64 v[28:29], v3 offset:0
    ds_read_b64 v[30:31], v3 offset:512
    v_exp_f32 v96, v96
    v_exp_f32 v97, v97
    v_exp_f32 v98, v98
    v_exp_f32 v99, v99
    v_cvt_pk_bf16_f32 v44, v96, v97
    v_cvt_pk_bf16_f32 v45, v98, v99
    v_mfma_f32_32x32x8_bf16 v[112:127], v[32:33], v[24:25], v[112:127]
    ds_read_b64 v[32:33], v4 offset:0
    v_exp_f32 v104, v104
    v_exp_f32 v105, v105
    v_exp_f32 v106, v106
    v_exp_f32 v107, v107
    v_cvt_pk_bf16_f32 v46, v104, v105
    v_cvt_pk_bf16_f32 v47, v106, v107
    v_mfma_f32_32x32x16_bf16 v[80:95], v[40:43], v[48:51], v[80:95]
    v_mov_b32 v40, v132
    v_mov_b32 v41, v133
    v_mov_b32 v42, v134
    v_mov_b32 v43, v135
    v_exp_f32 v100, v100
    v_exp_f32 v101, v101
    v_exp_f32 v102, v102
    v_exp_f32 v103, v103
    v_cvt_pk_bf16_f32 v48, v100, v101
    v_cvt_pk_bf16_f32 v49, v102, v103
    v_mfma_f32_32x32x16_bf16 v[64:79], v[36:39], v[44:47], v[64:79]
    v_exp_f32 v108, v108
    v_exp_f32 v109, v109
    v_exp_f32 v110, v110
    v_exp_f32 v111, v111
    v_cvt_pk_bf16_f32 v50, v108, v109
    v_cvt_pk_bf16_f32 v51, v110, v111
    s_waitcnt lgkmcnt(1)
    v_mfma_f32_32x32x16_bf16 v[96:111], v[28:31], v[12:15], 0
    v_exp_f32 v112, v112
    v_exp_f32 v113, v113
    v_exp_f32 v114, v114
    v_exp_f32 v115, v115
    v_cvt_pk_bf16_f32 v44, v112, v113
    v_cvt_pk_bf16_f32 v45, v114, v115
    s_waitcnt lgkmcnt(0)
    v_mfma_f32_32x32x8_bf16 v[96:111], v[32:33], v[16:17], v[96:111]
    v_exp_f32 v120, v120
    v_exp_f32 v121, v121
    v_exp_f32 v122, v122
    v_exp_f32 v123, v123
    v_cvt_pk_bf16_f32 v46, v120, v121
    v_cvt_pk_bf16_f32 v47, v122, v123
    v_mfma_f32_32x32x16_bf16 v[64:79], v[40:43], v[48:51], v[64:79]
    v_exp_f32 v116, v116
    v_exp_f32 v117, v117
    v_exp_f32 v118, v118
    v_exp_f32 v119, v119
    v_cvt_pk_bf16_f32 v48, v116, v117
    v_cvt_pk_bf16_f32 v49, v118, v119
    v_mfma_f32_32x32x16_bf16 v[80:95], v[36:39], v[44:47], v[80:95]
    ds_read_b128 v[36:39], v5 offset:1280
    v_exp_f32 v124, v124
    v_exp_f32 v125, v125
    v_exp_f32 v126, v126
    v_exp_f32 v127, v127
    v_cvt_pk_bf16_f32 v50, v124, v125
    v_cvt_pk_bf16_f32 v51, v126, v127
.p2align 6
K2_LOOP:
    s_bitcmp1_b32 s32, s24
    s_cbranch_scc1 K2_BAR0
K2_BODY0:
    s_add_u32 s24, s24, 1
    s_setprio 2
    v_mfma_f32_32x32x16_bf16 v[112:127], v[28:31], v[20:23], 0
    ds_read_b64 v[28:29], v3 offset:3968
    ds_read_b64 v[30:31], v3 offset:4480
    v_exp_f32 v96, v96
    v_exp_f32 v97, v97
    v_exp_f32 v98, v98
    v_exp_f32 v99, v99
    v_cvt_pk_bf16_f32 v44, v96, v97
    v_cvt_pk_bf16_f32 v45, v98, v99
    v_mfma_f32_32x32x8_bf16 v[112:127], v[32:33], v[24:25], v[112:127]
    ds_read_b64 v[32:33], v4 offset:3968
    v_exp_f32 v104, v104
    v_exp_f32 v105, v105
    v_exp_f32 v106, v106
    v_exp_f32 v107, v107
    v_cvt_pk_bf16_f32 v46, v104, v105
    v_cvt_pk_bf16_f32 v47, v106, v107
    v_mfma_f32_32x32x16_bf16 v[80:95], v[40:43], v[48:51], v[80:95]
    ds_read_b128 v[40:43], v18 offset:1280
    v_exp_f32 v100, v100
    v_exp_f32 v101, v101
    v_exp_f32 v102, v102
    v_exp_f32 v103, v103
    v_cvt_pk_bf16_f32 v48, v100, v101
    v_cvt_pk_bf16_f32 v49, v102, v103
    s_waitcnt lgkmcnt(4)
    v_mfma_f32_32x32x16_bf16 v[64:79], v[36:39], v[44:47], v[64:79]
    v_exp_f32 v108, v108
    v_exp_f32 v109, v109
    v_exp_f32 v110, v110
    v_exp_f32 v111, v111
    v_cvt_pk_bf16_f32 v50, v108, v109
    v_cvt_pk_bf16_f32 v51, v110, v111
    s_setprio 1
    s_waitcnt lgkmcnt(2)
    v_mfma_f32_32x32x16_bf16 v[96:111], v[28:31], v[12:15], 0
    v_exp_f32 v112, v112
    v_exp_f32 v113, v113
    v_exp_f32 v114, v114
    v_exp_f32 v115, v115
    v_cvt_pk_bf16_f32 v44, v112, v113
    v_cvt_pk_bf16_f32 v45, v114, v115
    s_waitcnt lgkmcnt(1)
    v_mfma_f32_32x32x8_bf16 v[96:111], v[32:33], v[16:17], v[96:111]
    v_exp_f32 v120, v120
    v_exp_f32 v121, v121
    v_exp_f32 v122, v122
    v_exp_f32 v123, v123
    v_cvt_pk_bf16_f32 v46, v120, v121
    v_cvt_pk_bf16_f32 v47, v122, v123
    s_waitcnt lgkmcnt(0)
    v_mfma_f32_32x32x16_bf16 v[64:79], v[40:43], v[48:51], v[64:79]
    v_exp_f32 v116, v116
    v_exp_f32 v117, v117
    v_exp_f32 v118, v118
    v_exp_f32 v119, v119
    v_cvt_pk_bf16_f32 v48, v116, v117
    v_cvt_pk_bf16_f32 v49, v118, v119
    v_mfma_f32_32x32x16_bf16 v[80:95], v[36:39], v[44:47], v[80:95]
    ds_read_b128 v[36:39], v19 offset:1280
    v_exp_f32 v124, v124
    v_exp_f32 v125, v125
    v_exp_f32 v126, v126
    v_exp_f32 v127, v127
    v_cvt_pk_bf16_f32 v50, v124, v125
    v_cvt_pk_bf16_f32 v51, v126, v127
    s_setprio 2
    v_mfma_f32_32x32x16_bf16 v[112:127], v[28:31], v[20:23], 0
    ds_read_b64 v[28:29], v3 offset:5248
    ds_read_b64 v[30:31], v3 offset:5760
    v_exp_f32 v96, v96
    v_exp_f32 v97, v97
    v_exp_f32 v98, v98
    v_exp_f32 v99, v99
    v_cvt_pk_bf16_f32 v44, v96, v97
    v_cvt_pk_bf16_f32 v45, v98, v99
    v_mfma_f32_32x32x8_bf16 v[112:127], v[32:33], v[24:25], v[112:127]
    ds_read_b64 v[32:33], v4 offset:5248
    v_exp_f32 v104, v104
    v_exp_f32 v105, v105
    v_exp_f32 v106, v106
    v_exp_f32 v107, v107
    v_cvt_pk_bf16_f32 v46, v104, v105
    v_cvt_pk_bf16_f32 v47, v106, v107
    v_mfma_f32_32x32x16_bf16 v[80:95], v[40:43], v[48:51], v[80:95]
    ds_read_b128 v[40:43], v26 offset:1280
    v_exp_f32 v100, v100
    v_exp_f32 v101, v101
    v_exp_f32 v102, v102
    v_exp_f32 v103, v103
    v_cvt_pk_bf16_f32 v48, v100, v101
    v_cvt_pk_bf16_f32 v49, v102, v103
    s_waitcnt lgkmcnt(4)
    v_mfma_f32_32x32x16_bf16 v[64:79], v[36:39], v[44:47], v[64:79]
    v_exp_f32 v108, v108
    v_exp_f32 v109, v109
    v_exp_f32 v110, v110
    v_exp_f32 v111, v111
    v_cvt_pk_bf16_f32 v50, v108, v109
    v_cvt_pk_bf16_f32 v51, v110, v111
    s_setprio 1
    s_waitcnt lgkmcnt(2)
    v_mfma_f32_32x32x16_bf16 v[96:111], v[28:31], v[12:15], 0
    v_exp_f32 v112, v112
    v_exp_f32 v113, v113
    v_exp_f32 v114, v114
    v_exp_f32 v115, v115
    v_cvt_pk_bf16_f32 v44, v112, v113
    v_cvt_pk_bf16_f32 v45, v114, v115
    s_waitcnt lgkmcnt(1)
    v_mfma_f32_32x32x8_bf16 v[96:111], v[32:33], v[16:17], v[96:111]
    v_exp_f32 v120, v120
    v_exp_f32 v121, v121
    v_exp_f32 v122, v122
    v_exp_f32 v123, v123
    v_cvt_pk_bf16_f32 v46, v120, v121
    v_cvt_pk_bf16_f32 v47, v122, v123
    s_waitcnt lgkmcnt(0)
    v_mfma_f32_32x32x16_bf16 v[64:79], v[40:43], v[48:51], v[64:79]
    v_exp_f32 v116, v116
    v_exp_f32 v117, v117
    v_exp_f32 v118, v118
    v_exp_f32 v119, v119
    v_cvt_pk_bf16_f32 v48, v116, v117
    v_cvt_pk_bf16_f32 v49, v118, v119
    v_mfma_f32_32x32x16_bf16 v[80:95], v[36:39], v[44:47], v[80:95]
    ds_read_b128 v[36:39], v5 offset:6528
    v_exp_f32 v124, v124
    v_exp_f32 v125, v125
    v_exp_f32 v126, v126
    v_exp_f32 v127, v127
    v_cvt_pk_bf16_f32 v50, v124, v125
    v_cvt_pk_bf16_f32 v51, v126, v127
    s_setprio 2
    v_mfma_f32_32x32x16_bf16 v[112:127], v[28:31], v[20:23], 0
    ds_read_b64 v[28:29], v3 offset:9216
    ds_read_b64 v[30:31], v3 offset:9728
    v_exp_f32 v96, v96
    v_exp_f32 v97, v97
    v_exp_f32 v98, v98
    v_exp_f32 v99, v99
    v_cvt_pk_bf16_f32 v44, v96, v97
    v_cvt_pk_bf16_f32 v45, v98, v99
    v_mfma_f32_32x32x8_bf16 v[112:127], v[32:33], v[24:25], v[112:127]
    ds_read_b64 v[32:33], v4 offset:9216
    v_exp_f32 v104, v104
    v_exp_f32 v105, v105
    v_exp_f32 v106, v106
    v_exp_f32 v107, v107
    v_cvt_pk_bf16_f32 v46, v104, v105
    v_cvt_pk_bf16_f32 v47, v106, v107
    v_mfma_f32_32x32x16_bf16 v[80:95], v[40:43], v[48:51], v[80:95]
    ds_read_b128 v[40:43], v18 offset:6528
    v_exp_f32 v100, v100
    v_exp_f32 v101, v101
    v_exp_f32 v102, v102
    v_exp_f32 v103, v103
    v_cvt_pk_bf16_f32 v48, v100, v101
    v_cvt_pk_bf16_f32 v49, v102, v103
    s_waitcnt lgkmcnt(4)
    v_mfma_f32_32x32x16_bf16 v[64:79], v[36:39], v[44:47], v[64:79]
    v_exp_f32 v108, v108
    v_exp_f32 v109, v109
    v_exp_f32 v110, v110
    v_exp_f32 v111, v111
    v_cvt_pk_bf16_f32 v50, v108, v109
    v_cvt_pk_bf16_f32 v51, v110, v111
    s_setprio 1
    s_waitcnt lgkmcnt(2)
    v_mfma_f32_32x32x16_bf16 v[96:111], v[28:31], v[12:15], 0
    v_exp_f32 v112, v112
    v_exp_f32 v113, v113
    v_exp_f32 v114, v114
    v_exp_f32 v115, v115
    v_cvt_pk_bf16_f32 v44, v112, v113
    v_cvt_pk_bf16_f32 v45, v114, v115
    s_waitcnt lgkmcnt(1)
    v_mfma_f32_32x32x8_bf16 v[96:111], v[32:33], v[16:17], v[96:111]
    v_exp_f32 v120, v120
    v_exp_f32 v121, v121
    v_exp_f32 v122, v122
    v_exp_f32 v123, v123
    v_cvt_pk_bf16_f32 v46, v120, v121
    v_cvt_pk_bf16_f32 v47, v122, v123
    s_waitcnt lgkmcnt(0)
    v_mfma_f32_32x32x16_bf16 v[64:79], v[40:43], v[48:51], v[64:79]
    v_exp_f32 v116, v116
    v_exp_f32 v117, v117
    v_exp_f32 v118, v118
    v_exp_f32 v119, v119
    v_cvt_pk_bf16_f32 v48, v116, v117
    v_cvt_pk_bf16_f32 v49, v118, v119
    v_mfma_f32_32x32x16_bf16 v[80:95], v[36:39], v[44:47], v[80:95]
    ds_read_b128 v[36:39], v19 offset:6528
    v_exp_f32 v124, v124
    v_exp_f32 v125, v125
    v_exp_f32 v126, v126
    v_exp_f32 v127, v127
    v_cvt_pk_bf16_f32 v50, v124, v125
    v_cvt_pk_bf16_f32 v51, v126, v127
    s_bitcmp1_b32 s32, s24
    s_cbranch_scc1 K2_BAR1
K2_BODY1:
    s_add_u32 s24, s24, 1
    s_setprio 2
    v_mfma_f32_32x32x16_bf16 v[112:127], v[28:31], v[20:23], 0
    ds_read_b64 v[28:29], v3 offset:10496
    ds_read_b64 v[30:31], v3 offset:11008
    v_exp_f32 v96, v96
    v_exp_f32 v97, v97
    v_exp_f32 v98, v98
    v_exp_f32 v99, v99
    v_cvt_pk_bf16_f32 v44, v96, v97
    v_cvt_pk_bf16_f32 v45, v98, v99
    v_mfma_f32_32x32x8_bf16 v[112:127], v[32:33], v[24:25], v[112:127]
    ds_read_b64 v[32:33], v4 offset:10496
    v_exp_f32 v104, v104
    v_exp_f32 v105, v105
    v_exp_f32 v106, v106
    v_exp_f32 v107, v107
    v_cvt_pk_bf16_f32 v46, v104, v105
    v_cvt_pk_bf16_f32 v47, v106, v107
    v_mfma_f32_32x32x16_bf16 v[80:95], v[40:43], v[48:51], v[80:95]
    ds_read_b128 v[40:43], v26 offset:6528
    v_exp_f32 v100, v100
    v_exp_f32 v101, v101
    v_exp_f32 v102, v102
    v_exp_f32 v103, v103
    v_cvt_pk_bf16_f32 v48, v100, v101
    v_cvt_pk_bf16_f32 v49, v102, v103
    s_waitcnt lgkmcnt(4)
    v_mfma_f32_32x32x16_bf16 v[64:79], v[36:39], v[44:47], v[64:79]
    v_exp_f32 v108, v108
    v_exp_f32 v109, v109
    v_exp_f32 v110, v110
    v_exp_f32 v111, v111
    v_cvt_pk_bf16_f32 v50, v108, v109
    v_cvt_pk_bf16_f32 v51, v110, v111
    s_setprio 1
    s_waitcnt lgkmcnt(2)
    v_mfma_f32_32x32x16_bf16 v[96:111], v[28:31], v[12:15], 0
    v_exp_f32 v112, v112
    v_exp_f32 v113, v113
    v_exp_f32 v114, v114
    v_exp_f32 v115, v115
    v_cvt_pk_bf16_f32 v44, v112, v113
    v_cvt_pk_bf16_f32 v45, v114, v115
    s_waitcnt lgkmcnt(1)
    v_mfma_f32_32x32x8_bf16 v[96:111], v[32:33], v[16:17], v[96:111]
    v_exp_f32 v120, v120
    v_exp_f32 v121, v121
    v_exp_f32 v122, v122
    v_exp_f32 v123, v123
    v_cvt_pk_bf16_f32 v46, v120, v121
    v_cvt_pk_bf16_f32 v47, v122, v123
    s_waitcnt lgkmcnt(0)
    v_mfma_f32_32x32x16_bf16 v[64:79], v[40:43], v[48:51], v[64:79]
    v_exp_f32 v116, v116
    v_exp_f32 v117, v117
    v_exp_f32 v118, v118
    v_exp_f32 v119, v119
    v_cvt_pk_bf16_f32 v48, v116, v117
    v_cvt_pk_bf16_f32 v49, v118, v119
    v_mfma_f32_32x32x16_bf16 v[80:95], v[36:39], v[44:47], v[80:95]
    ds_read_b128 v[36:39], v5 offset:11776
    v_exp_f32 v124, v124
    v_exp_f32 v125, v125
    v_exp_f32 v126, v126
    v_exp_f32 v127, v127
    v_cvt_pk_bf16_f32 v50, v124, v125
    v_cvt_pk_bf16_f32 v51, v126, v127
    s_setprio 2
    v_mfma_f32_32x32x16_bf16 v[112:127], v[28:31], v[20:23], 0
    ds_read_b64 v[28:29], v3 offset:14464
    ds_read_b64 v[30:31], v3 offset:14976
    v_exp_f32 v96, v96
    v_exp_f32 v97, v97
    v_exp_f32 v98, v98
    v_exp_f32 v99, v99
    v_cvt_pk_bf16_f32 v44, v96, v97
    v_cvt_pk_bf16_f32 v45, v98, v99
    v_mfma_f32_32x32x8_bf16 v[112:127], v[32:33], v[24:25], v[112:127]
    ds_read_b64 v[32:33], v4 offset:14464
    v_exp_f32 v104, v104
    v_exp_f32 v105, v105
    v_exp_f32 v106, v106
    v_exp_f32 v107, v107
    v_cvt_pk_bf16_f32 v46, v104, v105
    v_cvt_pk_bf16_f32 v47, v106, v107
    v_mfma_f32_32x32x16_bf16 v[80:95], v[40:43], v[48:51], v[80:95]
    ds_read_b128 v[40:43], v18 offset:11776
    v_exp_f32 v100, v100
    v_exp_f32 v101, v101
    v_exp_f32 v102, v102
    v_exp_f32 v103, v103
    v_cvt_pk_bf16_f32 v48, v100, v101
    v_cvt_pk_bf16_f32 v49, v102, v103
    s_waitcnt lgkmcnt(4)
    v_mfma_f32_32x32x16_bf16 v[64:79], v[36:39], v[44:47], v[64:79]
    v_exp_f32 v108, v108
    v_exp_f32 v109, v109
    v_exp_f32 v110, v110
    v_exp_f32 v111, v111
    v_cvt_pk_bf16_f32 v50, v108, v109
    v_cvt_pk_bf16_f32 v51, v110, v111
    s_setprio 1
    s_waitcnt lgkmcnt(2)
    v_mfma_f32_32x32x16_bf16 v[96:111], v[28:31], v[12:15], 0
    v_exp_f32 v112, v112
    v_exp_f32 v113, v113
    v_exp_f32 v114, v114
    v_exp_f32 v115, v115
    v_cvt_pk_bf16_f32 v44, v112, v113
    v_cvt_pk_bf16_f32 v45, v114, v115
    s_waitcnt lgkmcnt(1)
    v_mfma_f32_32x32x8_bf16 v[96:111], v[32:33], v[16:17], v[96:111]
    v_exp_f32 v120, v120
    v_exp_f32 v121, v121
    v_exp_f32 v122, v122
    v_exp_f32 v123, v123
    v_cvt_pk_bf16_f32 v46, v120, v121
    v_cvt_pk_bf16_f32 v47, v122, v123
    s_waitcnt lgkmcnt(0)
    v_mfma_f32_32x32x16_bf16 v[64:79], v[40:43], v[48:51], v[64:79]
    v_exp_f32 v116, v116
    v_exp_f32 v117, v117
    v_exp_f32 v118, v118
    v_exp_f32 v119, v119
    v_cvt_pk_bf16_f32 v48, v116, v117
    v_cvt_pk_bf16_f32 v49, v118, v119
    v_mfma_f32_32x32x16_bf16 v[80:95], v[36:39], v[44:47], v[80:95]
    ds_read_b128 v[36:39], v19 offset:11776
    v_exp_f32 v124, v124
    v_exp_f32 v125, v125
    v_exp_f32 v126, v126
    v_exp_f32 v127, v127
    v_cvt_pk_bf16_f32 v50, v124, v125
    v_cvt_pk_bf16_f32 v51, v126, v127
    s_setprio 2
    v_mfma_f32_32x32x16_bf16 v[112:127], v[28:31], v[20:23], 0
    ds_read_b64 v[28:29], v3 offset:15744
    ds_read_b64 v[30:31], v3 offset:16256
    v_exp_f32 v96, v96
    v_exp_f32 v97, v97
    v_exp_f32 v98, v98
    v_exp_f32 v99, v99
    v_cvt_pk_bf16_f32 v44, v96, v97
    v_cvt_pk_bf16_f32 v45, v98, v99
    v_mfma_f32_32x32x8_bf16 v[112:127], v[32:33], v[24:25], v[112:127]
    ds_read_b64 v[32:33], v4 offset:15744
    v_exp_f32 v104, v104
    v_exp_f32 v105, v105
    v_exp_f32 v106, v106
    v_exp_f32 v107, v107
    v_cvt_pk_bf16_f32 v46, v104, v105
    v_cvt_pk_bf16_f32 v47, v106, v107
    v_mfma_f32_32x32x16_bf16 v[80:95], v[40:43], v[48:51], v[80:95]
    ds_read_b128 v[40:43], v26 offset:11776
    v_exp_f32 v100, v100
    v_exp_f32 v101, v101
    v_exp_f32 v102, v102
    v_exp_f32 v103, v103
    v_cvt_pk_bf16_f32 v48, v100, v101
    v_cvt_pk_bf16_f32 v49, v102, v103
    s_waitcnt lgkmcnt(4)
    v_mfma_f32_32x32x16_bf16 v[64:79], v[36:39], v[44:47], v[64:79]
    v_exp_f32 v108, v108
    v_exp_f32 v109, v109
    v_exp_f32 v110, v110
    v_exp_f32 v111, v111
    v_cvt_pk_bf16_f32 v50, v108, v109
    v_cvt_pk_bf16_f32 v51, v110, v111
    s_setprio 1
    s_waitcnt lgkmcnt(2)
    v_mfma_f32_32x32x16_bf16 v[96:111], v[28:31], v[12:15], 0
    v_exp_f32 v112, v112
    v_exp_f32 v113, v113
    v_exp_f32 v114, v114
    v_exp_f32 v115, v115
    v_cvt_pk_bf16_f32 v44, v112, v113
    v_cvt_pk_bf16_f32 v45, v114, v115
    s_waitcnt lgkmcnt(1)
    v_mfma_f32_32x32x8_bf16 v[96:111], v[32:33], v[16:17], v[96:111]
    v_exp_f32 v120, v120
    v_exp_f32 v121, v121
    v_exp_f32 v122, v122
    v_exp_f32 v123, v123
    v_cvt_pk_bf16_f32 v46, v120, v121
    v_cvt_pk_bf16_f32 v47, v122, v123
    s_waitcnt lgkmcnt(0)
    v_mfma_f32_32x32x16_bf16 v[64:79], v[40:43], v[48:51], v[64:79]
    v_exp_f32 v116, v116
    v_exp_f32 v117, v117
    v_exp_f32 v118, v118
    v_exp_f32 v119, v119
    v_cvt_pk_bf16_f32 v48, v116, v117
    v_cvt_pk_bf16_f32 v49, v118, v119
    v_mfma_f32_32x32x16_bf16 v[80:95], v[36:39], v[44:47], v[80:95]
    ds_read_b128 v[36:39], v5 offset:17024
    v_exp_f32 v124, v124
    v_exp_f32 v125, v125
    v_exp_f32 v126, v126
    v_exp_f32 v127, v127
    v_cvt_pk_bf16_f32 v50, v124, v125
    v_cvt_pk_bf16_f32 v51, v126, v127
    v_add_u32 v3, 15744, v3
    v_add_u32 v4, 15744, v4
    v_add_u32 v5, 15744, v5
    v_add_u32 v18, 15744, v18
    v_add_u32 v19, 15744, v19
    v_add_u32 v26, 15744, v26
    s_cmp_lt_u32 s24, 10
    s_cbranch_scc1 K2_LOOP
    s_nop 1
    v_mfma_f32_32x32x16_bf16 v[80:95], v[40:43], v[48:51], v[80:95]
    s_and_b32 s30, s20, 3
    s_lshl_b32 s30, s30, 12
    s_add_u32 s30, s30, 51200
    s_mul_i32 s28, s25, 81920
    s_add_u32 s28, s28, s30
    s_xor_b32 s29, s25, 1
    s_mul_i32 s29, s29, 81920
    s_add_u32 s29, s29, s30
    v_add_u32 v6, s28, v2
    v_add_u32 v7, s29, v2
    s_add_u32 s22, s22, s25
    s_cmp_eq_u32 s25, 1
    s_cbranch_scc1 K2_X1
    s_nop 3
    ds_write_b128 v6, v[80:83] offset:0
    ds_write_b128 v6, v[84:87] offset:1024
    ds_write_b128 v6, v[88:91] offset:2048
    ds_write_b128 v6, v[92:95] offset:3072
    s_branch K2_X2
K2_X1:
    ds_write_b128 v6, v[64:67] offset:0
    ds_write_b128 v6, v[68:71] offset:1024
    ds_write_b128 v6, v[72:75] offset:2048
    ds_write_b128 v6, v[76:79] offset:3072
    s_nop 1
    v_mov_b32 v64, v80
    v_mov_b32 v65, v81
    v_mov_b32 v66, v82
    v_mov_b32 v67, v83
    v_mov_b32 v68, v84
    v_mov_b32 v69, v85
    v_mov_b32 v70, v86
    v_mov_b32 v71, v87
    v_mov_b32 v72, v88
    v_mov_b32 v73, v89
    v_mov_b32 v74, v90
    v_mov_b32 v75, v91
    v_mov_b32 v76, v92
    v_mov_b32 v77, v93
    v_mov_b32 v78, v94
    v_mov_b32 v79, v95
    v_mov_b32 v12, v20
    v_mov_b32 v13, v21
    v_mov_b32 v14, v22
    v_mov_b32 v15, v23
    v_mov_b32 v16, v24
    v_mov_b32 v17, v25
K2_X2:
    s_lshl_b32 s28, s21, 16
    s_add_u32 s34, s28, 0x007a0000
    s_lshl_b32 s28, s21, 14
    s_add_u32 s35, s28, 0x009a0000
    s_lshl_b32 s31, s22, 9
    v_and_b32 v8, 31, v1
    v_lshlrev_b32 v8, 4, v8
    v_add_u32 v8, s31, v8
    v_lshrrev_b32 v9, 5, v1
    v_lshl_add_u32 v56, v9, 15, v8
    v_lshrrev_b32 v8, 1, v8
    v_lshl_add_u32 v57, v9, 30, v8
    s_waitcnt lgkmcnt(0)
    s_barrier
    ds_read_b128 v[96:99], v7 offset:0
    ds_read_b128 v[100:103], v7 offset:1024
    ds_read_b128 v[104:107], v7 offset:2048
    ds_read_b128 v[108:111], v7 offset:3072
    v_mov_b32 v9, 0x21800000
    v_mov_b32 v10, 0x71800000
    v_mov_b32 v11, 0x7b800000
    s_waitcnt lgkmcnt(0)
    v_add_f32 v64, v64, v96
    v_add_f32 v65, v65, v97
    v_add_f32 v66, v66, v98
    v_add_f32 v67, v67, v99
    v_add_f32 v68, v68, v100
    v_add_f32 v69, v69, v101
    v_add_f32 v70, v70, v102
    v_add_f32 v71, v71, v103
    v_add_f32 v72, v72, v104
    v_add_f32 v73, v73, v105
    v_add_f32 v74, v74, v106
    v_add_f32 v75, v75, v107
    v_add_f32 v76, v76, v108
    v_cmp_gt_u32 vcc, 32, v1
    s_nop 1
    v_cndmask_b32 v76, v72, v76, vcc
    v_max3_f32 v7, abs(v64), abs(v65), abs(v66)
    v_max3_f32 v7, abs(v67), abs(v68), v7
    v_max3_f32 v7, abs(v69), abs(v70), v7
    v_max3_f32 v7, abs(v71), abs(v72), v7
    v_max3_f32 v7, abs(v73), abs(v74), v7
    v_max_f32 v7, abs(v75), v7
    v_add_f32 v8, v64, v65
    v_add_f32 v8, v8, v66
    v_add_f32 v8, v8, v67
    v_add_f32 v8, v8, v68
    v_add_f32 v8, v8, v69
    v_add_f32 v8, v8, v70
    v_add_f32 v8, v8, v71
    v_add_f32 v8, v8, v72
    v_add_f32 v8, v8, v73
    v_add_f32 v8, v8, v74
    v_add_f32 v8, v8, v75
    v_cmp_gt_f32 s[28:29], v76, v9
    v_cmp_lt_f32 s[30:31], v76, v10
    v_cmp_lt_f32 vcc, v7, v11
    s_nop 1
    s_and_b64 s[28:29], s[28:29], s[30:31]
    s_and_b64 s[28:29], s[28:29], vcc
    v_cmp_o_f32 vcc, v8, v8
    s_nop 1
    s_and_b64 s[28:29], s[28:29], vcc
    s_cmp_eq_u64 s[28:29], -1
    s_cbranch_scc0 K2_SLOW
K2_FIN:
    v_rcp_f32 v6, v76
    s_nop 0
    v_mul_f32 v64, v64, v6
    v_mul_f32 v65, v65, v6
    v_mul_f32 v66, v66, v6
    v_mul_f32 v67, v67, v6
    v_mul_f32 v68, v68, v6
    v_mul_f32 v69, v69, v6
    v_mul_f32 v70, v70, v6
    v_mul_f32 v71, v71, v6
    v_mul_f32 v72, v72, v6
    v_mul_f32 v73, v73, v6
    v_mul_f32 v74, v74, v6
    v_mul_f32 v75, v75, v6
    v_cvt_pk_bf16_f32 v64, v64, v65
    v_cvt_pk_bf16_f32 v65, v66, v67
    v_cvt_pk_bf16_f32 v66, v68, v69
    v_cvt_pk_bf16_f32 v67, v70, v71
    v_cvt_pk_bf16_f32 v68, v72, v73
    v_cvt_pk_bf16_f32 v69, v74, v75
    buffer_store_dwordx4 v[64:67], v56, s[12:15], s34 offen sc1
    buffer_store_dwordx2 v[68:69], v57, s[12:15], s35 offen sc1
    s_waitcnt vmcnt(0)
    s_barrier
K2_END:
    s_endpgm
K2_BAR1:
    s_barrier
    s_branch K2_BODY1
K2_BAR0:
    s_waitcnt vmcnt(0)
    s_barrier
    s_branch K2_BODY0
K2_SLOW:
    v_mov_b32 v58, 0xff800000
    s_mov_b32 s23, 0
    s_mov_b32 s24, 0
K2_SL0:
    s_bitcmp1_b32 s24, 0
    s_cselect_b32 s28, 1344, 0
    s_mov_b32 s29, 1280
    s_cselect_b32 s29, -1344, s29
    s_cselect_b32 s30, 64, 0
    s_add_u32 s28, s28, s23
    s_add_u32 s29, s29, s23
    s_add_u32 s24, s24, 1
    v_xor_b32 v7, s30, v54
    v_xor_b32 v8, 32, v7
    buffer_load_dwordx2 v[28:29], v52, s[16:19], s28 offen sc1
    buffer_load_dwordx2 v[30:31], v52, s[16:19], s28 offen offset:512 sc1
    buffer_load_dwordx2 v[32:33], v53, s[16:19], s28 offen sc1
    s_waitcnt vmcnt(0)
    v_mfma_f32_32x32x16_bf16 v[96:111], v[28:31], v[12:15], 0
    v_mfma_f32_32x32x8_bf16 v[96:111], v[32:33], v[16:17], v[96:111]
    s_nop 15
    s_nop 3
    v_max3_f32 v58, v96, v97, v58
    v_max3_f32 v58, v98, v99, v58
    v_max3_f32 v58, v100, v101, v58
    v_max3_f32 v58, v102, v103, v58
    v_max3_f32 v58, v104, v105, v58
    v_max3_f32 v58, v106, v107, v58
    v_max3_f32 v58, v108, v109, v58
    v_max3_f32 v58, v110, v111, v58
    s_add_u32 s23, s23, 2624
    s_cmp_lt_u32 s23, 167936
    s_cbranch_scc1 K2_SL0
    v_mov_b32 v10, v58
    s_nop 1
    v_permlane32_swap_b32 v58, v10
    v_max_f32 v58, v58, v10
    v_mov_b32 v64, 0
    v_mov_b32 v65, 0
    v_mov_b32 v66, 0
    v_mov_b32 v67, 0
    v_mov_b32 v68, 0
    v_mov_b32 v69, 0
    v_mov_b32 v70, 0
    v_mov_b32 v71, 0
    v_mov_b32 v72, 0
    v_mov_b32 v73, 0
    v_mov_b32 v74, 0
    v_mov_b32 v75, 0
    v_mov_b32 v76, 0
    v_mov_b32 v77, 0
    v_mov_b32 v78, 0
    v_mov_b32 v79, 0
    s_mov_b32 s23, 0
    s_mov_b32 s24, 0
K2_SL1:
    s_bitcmp1_b32 s24, 0
    s_cselect_b32 s28, 1344, 0
    s_mov_b32 s29, 1280
    s_cselect_b32 s29, -1344, s29
    s_cselect_b32 s30, 64, 0
    s_add_u32 s28, s28, s23
    s_add_u32 s29, s29, s23
    s_add_u32 s24, s24, 1
    v_xor_b32 v7, s30, v54
    v_xor_b32 v8, 32, v7
    buffer_load_dwordx2 v[28:29], v52, s[16:19], s28 offen sc1
    buffer_load_dwordx2 v[30:31], v52, s[16:19], s28 offen offset:512 sc1
    buffer_load_dwordx2 v[32:33], v53, s[16:19], s28 offen sc1
    buffer_load_dwordx4 v[36:39], v7, s[16:19], s29 offen sc1
    buffer_load_dwordx4 v[40:43], v8, s[16:19], s29 offen sc1
    s_waitcnt vmcnt(0)
    v_mfma_f32_32x32x16_bf16 v[96:111], v[28:31], v[12:15], 0
    v_mfma_f32_32x32x8_bf16 v[96:111], v[32:33], v[16:17], v[96:111]
    s_nop 15
    s_nop 3
    v_sub_f32 v96, v96, v58
    v_sub_f32 v97, v97, v58
    v_sub_f32 v98, v98, v58
    v_sub_f32 v99, v99, v58
    v_sub_f32 v100, v100, v58
    v_sub_f32 v101, v101, v58
    v_sub_f32 v102, v102, v58
    v_sub_f32 v103, v103, v58
    v_sub_f32 v104, v104, v58
    v_sub_f32 v105, v105, v58
    v_sub_f32 v106, v106, v58
    v_sub_f32 v107, v107, v58
    v_sub_f32 v108, v108, v58
    v_sub_f32 v109, v109, v58
    v_sub_f32 v110, v110, v58
    v_sub_f32 v111, v111, v58
    v_exp_f32 v96, v96
    v_exp_f32 v97, v97
    v_exp_f32 v98, v98
    v_exp_f32 v99, v99
    v_exp_f32 v100, v100
    v_exp_f32 v101, v101
    v_exp_f32 v102, v102
    v_exp_f32 v103, v103
    v_exp_f32 v104, v104
    v_exp_f32 v105, v105
    v_exp_f32 v106, v106
    v_exp_f32 v107, v107
    v_exp_f32 v108, v108
    v_exp_f32 v109, v109
    v_exp_f32 v110, v110
    v_exp_f32 v111, v111
    s_nop 0
    v_cvt_pk_bf16_f32 v44, v96, v97
    v_cvt_pk_bf16_f32 v45, v98, v99
    v_cvt_pk_bf16_f32 v46, v104, v105
    v_cvt_pk_bf16_f32 v47, v106, v107
    v_cvt_pk_bf16_f32 v48, v100, v101
    v_cvt_pk_bf16_f32 v49, v102, v103
    v_cvt_pk_bf16_f32 v50, v108, v109
    v_cvt_pk_bf16_f32 v51, v110, v111
    s_nop 1
    v_mfma_f32_32x32x16_bf16 v[64:79], v[36:39], v[44:47], v[64:79]
    v_mfma_f32_32x32x16_bf16 v[64:79], v[40:43], v[48:51], v[64:79]
    s_nop 7
    s_add_u32 s23, s23, 2624
    s_cmp_lt_u32 s23, 167936
    s_cbranch_scc1 K2_SL1
    s_nop 15
    s_nop 3
    v_cmp_gt_u32 vcc, 32, v1
    s_nop 1
    v_cndmask_b32 v76, v72, v76, vcc
    s_branch K2_FIN
CODE_END:
    s_endpgm
.section .rodata,"a"
.p2align 6
.amdhsa_kernel parallel_sum__mha_block__dense_activation_gelu__prompt_kernel
  .amdhsa_next_free_vgpr 168
  .amdhsa_next_free_sgpr 80
  .amdhsa_accum_offset 168
  .amdhsa_group_segment_fixed_size 0
  .amdhsa_kernarg_size 88
  .amdhsa_user_sgpr_count 2
  .amdhsa_user_sgpr_kernarg_segment_ptr 1
  .amdhsa_system_sgpr_workgroup_id_x 1
.end_amdhsa_kernel
```
